```python
import torch

def _softmax(x, axis=-1):
    return torch.softmax(x, dim=axis)
def _gelu(x):
    return torch.nn.functional.gelu(x, approximate="tanh")
def _silu(x):
    return torch.nn.functional.silu(x)
def _sigmoid(x):
    return torch.sigmoid(x)
def _layernorm(x, axis=-1, eps=1e-5):
    m = x.mean(dim=axis, keepdim=True)
    v = x.var(dim=axis, keepdim=True, unbiased=False)
    return (x - m) / torch.sqrt(v + eps)
def _scatter_add(tgt, idx, src, axis=0):
    return tgt.clone().index_add_(axis, idx, src)
def _segment_sum(src, seg, n):
    out = torch.zeros((n,) + src.shape[1:], dtype=src.dtype)
    return out.index_add_(0, seg, src)
def _pad(x, pw):
    flat = tuple(v for pair in reversed(pw) for v in pair)
    return torch.nn.functional.pad(x, flat)

kernel_name = 'standalone__cheap_equivariant_egnn__graph'

def setup_inputs():

    _w = (lambda a: (lambda t: t.to(torch.bfloat16) if t.is_floating_point() else t)(torch.as_tensor(a)))
    N, deg, D, De = 25000, 32, 64, max(4, 1)
    E = N * deg
    return {
        "h": _w((lambda *s: torch.randn(*s, dtype=torch.bfloat16) * 0.2)(N, D)),
        "pos": _w((lambda *s: torch.randn(*s, dtype=torch.bfloat16) * 0.8)(N, 3)),
        "e_attr": _w((lambda *s: torch.randn(*s, dtype=torch.bfloat16) * 0.8)(E, De)),
        "src": _w((lambda lo, hi, *s: torch.randint(lo, hi, s))(0, N, E).to(torch.int64)),
        "dst": _w((lambda lo, hi, *s: torch.randint(lo, hi, s))(0, N, E).to(torch.int64)),
        "w_e": _w(0.1 * (lambda *s: torch.randn(*s, dtype=torch.bfloat16) * 0.8)(2 * D + 1 + De, D)),
        "w_x": _w(0.1 * (lambda *s: torch.randn(*s, dtype=torch.bfloat16) * 0.2)(D, 1)),
        "w_h": _w(0.1 * (lambda *s: torch.randn(*s, dtype=torch.bfloat16) * 0.2)(2 * D, D)),
    }

def reference(h, pos, e_attr, src, dst, w_e, w_x, w_h):
    N, D = h.shape[0], h.shape[1]
    diff = pos[dst] - pos[src]
    dist2 = torch.sum(diff * diff, axis=-1, keepdims=True)
    e_in = torch.concatenate([h[dst], h[src], dist2, e_attr], axis=-1)
    m_ij = _silu(e_in @ w_e)
    coord_scale = m_ij @ w_x
    pos_new = pos + _segment_sum(diff * coord_scale, dst, N)
    m_i = _segment_sum(m_ij, dst, N)
    h_new = h + _silu(torch.concatenate([h, m_i], axis=-1) @ w_h)
    return h_new, pos_new
```

```asm
; @launch kernel=bin_kernel grid=(255,1,1) block=(800,1,1) lds=40448
; @launch kernel=egnn_kernel grid=(256,1,1) block=(512,1,1) lds=162832
.amdgcn_target "amdgcn-amd-amdhsa--gfx950"
.text
.globl bin_kernel
.p2align 8
.type bin_kernel,@function
bin_kernel:
    s_cmp_ge_u32 s2, 255
    s_cbranch_scc1 K1_END

    s_load_dwordx16 s[16:31], s[0:1], 0
    s_load_dwordx2 s[32:33], s[0:1], 80
    s_waitcnt lgkmcnt(0)

    s_mov_b32 s48, s32
    s_and_b32 s49, s33, 0xffff
    s_mov_b32 s50, 0x10000000
    s_mov_b32 s51, 0x20000
    s_cmp_ge_u32 s2, 250
    s_cbranch_scc1 K1_IMG

    s_mov_b32 s36, s24
    s_and_b32 s37, s25, 0xffff
    s_mov_b32 s38, 3200000
    s_mov_b32 s39, 0x20000
    s_mov_b32 s40, s22
    s_and_b32 s41, s23, 0xffff
    s_mov_b32 s42, 3200000
    s_mov_b32 s43, 0x20000
    s_mov_b32 s44, s20
    s_and_b32 s45, s21, 0xffff
    s_mov_b32 s46, 6400000
    s_mov_b32 s47, 0x20000
    s_mov_b32 s52, s18
    s_and_b32 s53, s19, 0xffff
    s_mov_b32 s54, 150000
    s_mov_b32 s55, 0x20000

    s_mul_i32 s3, s2, 100
    v_add_u32 v3, s3, v0
    v_mul_u32_u24 v1, 6, v3
    v_mov_b32 v20, 0
    v_cmp_gt_u32 vcc, 100, v0
    s_and_saveexec_b64 s[4:5], vcc
    s_cbranch_execz K1_NOPOS1
    buffer_load_ushort v20, v1, s[52:55], 0 offen
    buffer_load_ushort v40, v1, s[52:55], 0 offen offset:2
    buffer_load_ushort v21, v1, s[52:55], 0 offen offset:4
K1_NOPOS1:
    s_mov_b64 exec, s[4:5]
    s_mul_i32 s3, s2, 12800
    v_lshl_add_u32 v1, v0, 4, s3
    v_lshlrev_b32 v2, 1, v1
    buffer_load_dwordx4 v[4:7], v1, s[36:39], 0 offen nt
    buffer_load_dwordx4 v[8:11], v1, s[40:43], 0 offen nt
    buffer_load_dwordx4 v[12:15], v2, s[44:47], 0 offen nt
    buffer_load_dwordx4 v[16:19], v2, s[44:47], 0 offen offset:16 nt

    v_lshlrev_b32 v22, 2, v0
    v_mov_b32 v23, 0
    v_cmp_gt_u32 vcc, 256, v0
    s_and_saveexec_b64 s[4:5], vcc
    ds_write_b32 v22, v23 offset:38400
    s_mov_b64 exec, s[4:5]
    v_mov_b32 v23, 1
    s_waitcnt lgkmcnt(0)
    s_barrier
    s_waitcnt vmcnt(3)

    v_cmp_gt_u32 vcc, 100, v0
    s_and_saveexec_b64 s[4:5], vcc
    s_cbranch_execz K1_NOPOS2
    v_lshlrev_b32 v42, 16, v21
    v_lshlrev_b32 v41, 16, v40
    v_lshlrev_b32 v40, 16, v20
    v_mov_b32 v43, 0
    v_lshlrev_b32 v3, 4, v3
    v_add_u32 v3, 11010048, v3
    buffer_store_dwordx4 v[40:43], v3, s[48:51], 0 offen
    s_nop 1
K1_NOPOS2:
    s_mov_b64 exec, s[4:5]

    v_mul_u32_u24 v24, 0xa730, v4
    v_lshrrev_b32 v24, 22, v24
    v_mul_u32_u24 v28, 98, v24
    v_sub_u32 v28, v4, v28
    v_lshlrev_b32 v24, 2, v24
    ds_add_rtn_u32 v32, v24, v23 offset:38400

    v_mul_u32_u24 v25, 0xa730, v5
    v_lshrrev_b32 v25, 22, v25
    v_mul_u32_u24 v29, 98, v25
    v_sub_u32 v29, v5, v29
    v_lshlrev_b32 v25, 2, v25
    ds_add_rtn_u32 v33, v25, v23 offset:38400

    v_mul_u32_u24 v26, 0xa730, v6
    v_lshrrev_b32 v26, 22, v26
    v_mul_u32_u24 v30, 98, v26
    v_sub_u32 v30, v6, v30
    v_lshlrev_b32 v26, 2, v26
    ds_add_rtn_u32 v34, v26, v23 offset:38400

    v_mul_u32_u24 v27, 0xa730, v7
    v_lshrrev_b32 v27, 22, v27
    v_mul_u32_u24 v31, 98, v27
    v_sub_u32 v31, v7, v31
    v_lshlrev_b32 v27, 2, v27
    ds_add_rtn_u32 v35, v27, v23 offset:38400

    v_lshrrev_b32 v22, 6, v0
    s_waitcnt lgkmcnt(0)
    s_barrier

    v_readfirstlane_b32 s6, v22
    s_nop 3
    s_cmp_lg_u32 s6, 0
    s_cbranch_scc1 K1_NOSCAN
    v_lshlrev_b32 v22, 4, v0
    ds_read_b128 v[36:39], v22 offset:38400
    s_waitcnt lgkmcnt(0)
    v_add_u32 v41, v36, v37
    v_add_u32 v42, v41, v38
    v_add_u32 v43, v42, v39
    v_mov_b32 v44, v43
    s_nop 1
    v_add_u32_dpp v44, v44, v44 row_shr:1 row_mask:0xf bank_mask:0xf bound_ctrl:0
    s_nop 1
    v_add_u32_dpp v44, v44, v44 row_shr:2 row_mask:0xf bank_mask:0xf bound_ctrl:0
    s_nop 1
    v_add_u32_dpp v44, v44, v44 row_shr:4 row_mask:0xf bank_mask:0xf bound_ctrl:0
    s_nop 1
    v_add_u32_dpp v44, v44, v44 row_shr:8 row_mask:0xf bank_mask:0xf bound_ctrl:0
    s_nop 1
    v_add_u32_dpp v44, v44, v44 row_bcast:15 row_mask:0xa bank_mask:0xf
    s_nop 1
    v_add_u32_dpp v44, v44, v44 row_bcast:31 row_mask:0xc bank_mask:0xf
    s_nop 1
    v_sub_u32 v44, v44, v43
    v_add_u32 v45, v44, v36
    v_add_u32 v46, v44, v41
    v_add_u32 v47, v44, v42
    ds_write_b128 v22, v[44:47] offset:39424
    v_lshl_or_b32 v36, v36, 16, v44
    v_lshl_or_b32 v37, v37, 16, v45
    v_lshl_or_b32 v38, v38, 16, v46
    v_lshl_or_b32 v39, v39, 16, v47
    s_lshl_b32 s3, s2, 10
    s_add_u32 s3, s3, 10485760
    v_add_u32 v22, s3, v22
    buffer_store_dwordx4 v[36:39], v22, s[48:51], 0 offen
    s_waitcnt lgkmcnt(0)
K1_NOSCAN:
    s_barrier

    ds_read_b32 v36, v24 offset:39424
    ds_read_b32 v37, v25 offset:39424
    ds_read_b32 v38, v26 offset:39424
    ds_read_b32 v39, v27 offset:39424
    s_waitcnt vmcnt(0)

    v_lshl_add_u32 v8, v28, 20, v8
    v_lshl_add_u32 v9, v29, 20, v9
    v_lshl_add_u32 v10, v30, 20, v10
    v_lshl_add_u32 v11, v31, 20, v11
    s_waitcnt lgkmcnt(0)
    v_add_u32 v36, v36, v32
    v_mul_u32_u24 v36, 12, v36
    ds_write2_b32 v36, v12, v13 offset0:0 offset1:1
    ds_write_b32 v36, v8 offset:8

    v_add_u32 v37, v37, v33
    v_mul_u32_u24 v37, 12, v37
    ds_write2_b32 v37, v14, v15 offset0:0 offset1:1
    ds_write_b32 v37, v9 offset:8

    v_add_u32 v38, v38, v34
    v_mul_u32_u24 v38, 12, v38
    ds_write2_b32 v38, v16, v17 offset0:0 offset1:1
    ds_write_b32 v38, v10 offset:8

    v_add_u32 v39, v39, v35
    v_mul_u32_u24 v39, 12, v39
    ds_write2_b32 v39, v18, v19 offset0:0 offset1:1
    ds_write_b32 v39, v11 offset:8

    v_lshlrev_b32 v22, 4, v0
    s_mul_i32 s3, s2, 38400
    v_add_u32 v1, s3, v22
    s_waitcnt lgkmcnt(0)
    s_barrier

    ds_read_b128 v[4:7], v22
    ds_read_b128 v[8:11], v22 offset:12800
    ds_read_b128 v[12:15], v22 offset:25600
    v_add_u32 v2, 12800, v1
    v_add_u32 v3, 25600, v1
    s_waitcnt lgkmcnt(2)
    buffer_store_dwordx4 v[4:7], v1, s[48:51], 0 offen nt
    s_waitcnt lgkmcnt(1)
    buffer_store_dwordx4 v[8:11], v2, s[48:51], 0 offen nt
    s_waitcnt lgkmcnt(0)
    buffer_store_dwordx4 v[12:15], v3, s[48:51], 0 offen nt

    s_endpgm

K1_IMG:
    s_cmp_eq_u32 s2, 254
    s_cbranch_scc1 K1_IMGX2
    v_cmp_gt_u32 vcc, 512, v0
    s_and_saveexec_b64 s[4:5], vcc
    s_cbranch_execz K1_END
    s_cmp_ge_u32 s2, 252
    s_cselect_b32 s56, s30, s26
    s_cselect_b32 s57, s31, s27
    s_mov_b32 s58, 17024
    s_cselect_b32 s58, 16384, s58
    s_cselect_b64 s[8:9], -1, 0
    s_and_b32 s57, s57, 0xffff
    s_mov_b32 s59, 0x20000
    s_cmp_eq_u32 s2, 250
    s_cselect_b32 s6, 64, 0
    s_cmp_eq_u32 s2, 253
    s_cselect_b32 s7, 64, s6
    s_sub_u32 s3, s2, 250
    s_lshl_b32 s3, s3, 13
    s_add_u32 s3, s3, 11534336
    v_lshrrev_b32 v1, 7, v0
    v_bfe_u32 v2, v0, 6, 1
    v_bfe_u32 v3, v0, 5, 1
    v_and_b32 v4, 31, v0
    v_bfe_u32 v5, v4, 2, 1
    v_lshlrev_b32 v5, 4, v5
    v_lshrrev_b32 v6, 3, v4
    v_lshl_add_u32 v5, v6, 2, v5
    v_and_b32 v6, 3, v4
    v_add_u32 v5, v5, v6
    v_cndmask_b32 v4, v4, v5, s[8:9]
    v_lshl_add_u32 v4, v2, 5, v4
    v_lshlrev_b32 v1, 4, v1
    v_lshl_add_u32 v1, v3, 3, v1
    v_add_u32 v1, s7, v1
    v_lshlrev_b32 v1, 7, v1
    v_lshl_add_u32 v1, v4, 1, v1

    buffer_load_ushort v12, v1, s[56:59], 0 offen offset:0
    buffer_load_ushort v13, v1, s[56:59], 0 offen offset:128
    buffer_load_ushort v14, v1, s[56:59], 0 offen offset:256
    buffer_load_ushort v15, v1, s[56:59], 0 offen offset:384
    buffer_load_ushort v16, v1, s[56:59], 0 offen offset:512
    buffer_load_ushort v17, v1, s[56:59], 0 offen offset:640
    buffer_load_ushort v18, v1, s[56:59], 0 offen offset:768
    buffer_load_ushort v19, v1, s[56:59], 0 offen offset:896
    v_lshl_add_u32 v2, v0, 4, s3
    s_waitcnt vmcnt(0)
    v_lshl_or_b32 v8, v13, 16, v12
    v_lshl_or_b32 v9, v15, 16, v14
    v_lshl_or_b32 v10, v17, 16, v16
    v_lshl_or_b32 v11, v19, 16, v18
    buffer_store_dwordx4 v[8:11], v2, s[48:51], 0 offen
    s_endpgm
K1_IMGX2:
    v_cmp_gt_u32 vcc, 128, v0
    s_and_saveexec_b64 s[4:5], vcc
    s_cbranch_execz K1_END

    s_mov_b32 s56, s26
    s_and_b32 s57, s27, 0xffff
    s_mov_b32 s58, 17024
    s_mov_b32 s59, 0x20000
    v_mov_b32 v8, 0
    v_mov_b32 v9, 0
    v_mov_b32 v10, 0
    v_mov_b32 v11, 0
    v_bfe_u32 v2, v0, 6, 1
    v_and_b32 v4, 31, v0
    v_lshl_add_u32 v4, v2, 5, v4
    v_lshlrev_b32 v1, 1, v4
    v_add_u32 v1, 16384, v1
    v_lshlrev_b32 v2, 4, v0
    v_add_u32 v2, 11532288, v2
    v_and_b32 v3, 32, v0
    v_cmp_eq_u32 vcc, 0, v3
    s_and_saveexec_b64 s[6:7], vcc
    buffer_load_ushort v8, v1, s[56:59], 0 offen offset:128
    buffer_load_ushort v12, v1, s[56:59], 0 offen offset:256
    buffer_load_ushort v9, v1, s[56:59], 0 offen offset:384
    buffer_load_ushort v13, v1, s[56:59], 0 offen offset:512
    buffer_load_ushort v10, v1, s[56:59], 0 offen
    s_waitcnt vmcnt(0)
    v_lshl_or_b32 v8, v12, 16, v8
    v_lshl_or_b32 v9, v13, 16, v9
    s_mov_b64 exec, s[6:7]
    buffer_store_dwordx4 v[8:11], v2, s[48:51], 0 offen
K1_END:
    s_endpgm

.globl egnn_kernel
.p2align 8
.type egnn_kernel,@function
egnn_kernel:
    s_cmp_ge_u32 s2, 256
    s_cbranch_scc1 K2_END
    s_load_dwordx16 s[16:31], s[0:1], 0
    s_load_dwordx2 s[32:33], s[0:1], 80
    s_load_dwordx2 s[34:35], s[0:1], 64
    v_lshrrev_b32 v1, 6, v0
    s_nop 0
    v_readfirstlane_b32 s3, v1
    s_mul_i32 s4, s2, 98
    s_mov_b32 s8, 0xffffff80
    s_mov_b32 s9, 0xbfb8aa3b
    s_mov_b32 s92, 0xbfb8aa3b
    s_mov_b32 s93, 0xbfb8aa3b
    s_mov_b32 s10, 0
    s_mov_b32 s11, -1
    s_mov_b32 s6, 0
    s_lshl_b32 s5, s3, 12
    s_add_u32 s5, s5, 130064
    s_lshl_b32 s7, s3, 11
    s_add_u32 s7, s7, 87056
    v_and_b32 v1, 63, v0
    v_mov_b32 v225, 0
    s_waitcnt lgkmcnt(0)
    s_add_u32 s48, s32, 10485760
    s_addc_u32 s49, s33, 0
    s_and_b32 s49, s49, 0xffff
    s_mov_b32 s50, 256000
    s_mov_b32 s51, 0x20000

    v_bfe_u32 v2, v1, 3, 2
    v_and_b32 v3, 7, v1
    v_lshl_add_u32 v2, v3, 5, v2
    s_lshl_b32 s19, s3, 12
    s_lshl_b32 s20, s2, 2
    s_add_u32 s19, s19, s20
    v_lshl_add_u32 v3, v2, 10, s19
    buffer_load_dword v39, v3, s[48:51], 0 offen
    v_lshrrev_b32 v2, 4, v0
    v_and_b32 v5, 15, v0
    v_add_u32 v5, s6, v5
    v_add_u32 v4, 16, v5
    v_mul_u32_u24 v6, 3200, v2
    v_add_u32 v6, v6, v5
    v_mov_b32 v7, 0x80000000
    v_mov_b32 v52, 0
    v_lshrrev_b32 v38, 4, v1
    v_lshlrev_b32 v38, 5, v38

    s_mov_b32 s36, s16
    s_and_b32 s37, s17, 0xffff
    s_mov_b32 s38, 3200000
    s_mov_b32 s39, 0x20000
    s_mov_b32 s44, s32
    s_and_b32 s45, s33, 0xffff
    s_mov_b32 s46, 0x10000000
    s_mov_b32 s47, 0x20000
    s_mov_b32 s52, s34
    s_and_b32 s53, s35, 0xffff
    s_mov_b32 s54, 3350000
    s_mov_b32 s55, 0x20000
    s_add_u32 s40, s32, 11010048
    s_addc_u32 s41, s33, 0
    s_and_b32 s41, s41, 0xffff
    s_or_b32 s41, s41, 1048576
    s_mov_b32 s42, 25000
    s_mov_b32 s43, 0x20000
    s_mov_b32 s94, 1

    s_mov_b32 s56, s28
    s_and_b32 s57, s29, 0xffff
    s_mov_b32 s58, 128
    s_mov_b32 s59, 0x20000
    v_lshlrev_b32 v53, 4, v1
    v_and_b32 v54, 7, v1
    v_lshrrev_b32 v55, 4, v1
    v_xor_b32 v54, v54, v55
    v_lshlrev_b32 v54, 4, v54
    v_lshrrev_b32 v55, 3, v1
    v_lshl_add_u32 v54, v55, 7, v54
    v_xor_b32 v55, 64, v54

    s_lshl_b32 s19, s3, 2
    s_add_u32 s19, s19, 0
    s_lshl_b32 s20, s19, 10
    s_add_u32 m0, s20, 130064
    s_cmp_ge_u32 s19, 18
    s_cbranch_scc1 K2_DH0
    s_add_u32 s20, s20, 11532288
    buffer_load_dwordx4 v53, s[44:47], s20 offen lds
    s_branch K2_DE0
K2_DH0:
    s_lshl_b32 s21, s4, 7
    s_add_u32 s20, s20, s21
    s_sub_u32 s20, s20, 18432
    buffer_load_dwordx4 v54, s[36:39], s20 offen lds
K2_DE0:

    s_lshl_b32 s19, s3, 2
    s_add_u32 s19, s19, 1
    s_lshl_b32 s20, s19, 10
    s_add_u32 m0, s20, 130064
    s_cmp_ge_u32 s19, 18
    s_cbranch_scc1 K2_DH1
    s_add_u32 s20, s20, 11532288
    buffer_load_dwordx4 v53, s[44:47], s20 offen lds
    s_branch K2_DE1
K2_DH1:
    s_lshl_b32 s21, s4, 7
    s_add_u32 s20, s20, s21
    s_sub_u32 s20, s20, 18432
    buffer_load_dwordx4 v55, s[36:39], s20 offen lds
K2_DE1:

    s_lshl_b32 s19, s3, 2
    s_add_u32 s19, s19, 2
    s_lshl_b32 s20, s19, 10
    s_add_u32 m0, s20, 130064
    s_cmp_ge_u32 s19, 18
    s_cbranch_scc1 K2_DH2
    s_add_u32 s20, s20, 11532288
    buffer_load_dwordx4 v53, s[44:47], s20 offen lds
    s_branch K2_DE2
K2_DH2:
    s_lshl_b32 s21, s4, 7
    s_add_u32 s20, s20, s21
    s_sub_u32 s20, s20, 18432
    buffer_load_dwordx4 v54, s[36:39], s20 offen lds
K2_DE2:

    s_lshl_b32 s19, s3, 2
    s_add_u32 s19, s19, 3
    s_lshl_b32 s20, s19, 10
    s_add_u32 m0, s20, 130064
    s_cmp_ge_u32 s19, 18
    s_cbranch_scc1 K2_DH3
    s_add_u32 s20, s20, 11532288
    buffer_load_dwordx4 v53, s[44:47], s20 offen lds
    s_branch K2_DE3
K2_DH3:
    s_lshl_b32 s21, s4, 7
    s_add_u32 s20, s20, s21
    s_sub_u32 s20, s20, 18432
    buffer_load_dwordx4 v55, s[36:39], s20 offen lds
K2_DE3:

    v_add_u32 v54, s4, v0
    v_cmp_gt_u32 vcc, 104, v0
    s_nop 1
    v_cndmask_b32 v54, v7, v54, vcc
    buffer_load_dwordx4 v[240:243], v54, s[40:43], 0 idxen
    v_bfe_u32 v54, v0, 4, 1
    v_lshlrev_b32 v54, 5, v54
    v_bfe_u32 v55, v0, 2, 2
    v_lshl_add_u32 v54, v55, 3, v54
    v_bfe_u32 v55, v0, 5, 1
    v_lshl_add_u32 v54, v55, 2, v54
    v_and_b32 v55, 3, v0
    v_add_u32 v54, v54, v55
    v_lshlrev_b32 v54, 1, v54
    buffer_load_ushort v62, v54, s[56:59], 0 offen

    v_mov_b32 v56, 0
    v_mov_b32 v57, 0
    v_mov_b32 v58, 0
    v_mov_b32 v59, 0
    v_lshlrev_b32 v54, 2, v0
    v_mul_u32_u24 v55, 1408, v0
    v_cmp_gt_u32 vcc, 16, v0
    s_nop 1
    v_cndmask_b32 v55, 0, v55, vcc
    v_cmp_gt_u32 vcc, 36, v0
    s_and_saveexec_b64 s[96:97], vcc
    ds_write_b32 v54, v55 offset:2048
    s_mov_b64 exec, s[96:97]
    v_lshrrev_b32 v54, 3, v0
    v_and_b32 v55, 3, v0
    v_cmp_eq_u32 vcc, v54, v55
    v_bfe_u32 v54, v0, 2, 1
    v_lshlrev_b32 v54, 4, v54
    v_mov_b32 v55, 0x3f80
    v_lshlrev_b32 v55, v54, v55
    v_cndmask_b32 v55, 0, v55, vcc
    v_lshlrev_b32 v54, 2, v0
    v_cmp_gt_u32 vcc, 32, v0
    s_and_saveexec_b64 s[96:97], vcc
    ds_write_b32 v54, v55 offset:0
    s_mov_b64 exec, s[96:97]
    s_waitcnt vmcnt(6)

    ds_bpermute_b32 v40, v38, v39 offset:0
    ds_bpermute_b32 v41, v38, v39 offset:4
    ds_bpermute_b32 v42, v38, v39 offset:8
    ds_bpermute_b32 v43, v38, v39 offset:12
    ds_bpermute_b32 v44, v38, v39 offset:16
    ds_bpermute_b32 v45, v38, v39 offset:20
    ds_bpermute_b32 v46, v38, v39 offset:24
    ds_bpermute_b32 v47, v38, v39 offset:28
    s_waitcnt lgkmcnt(0)
    v_lshrrev_b32 v48, 16, v40
    v_and_b32 v49, 0xffff, v40
    v_add_u32 v49, v49, v6
    v_add_u32 v49, 0, v49
    v_mul_u32_u24 v24, 12, v49
    v_cmp_lt_u32 s[60:61], v5, v48
    v_cmp_lt_u32 s[62:63], v4, v48
    v_subrev_u32 v48, s6, v48
    v_max_i32 v52, v52, v48

    v_lshrrev_b32 v48, 16, v41
    v_and_b32 v49, 0xffff, v41
    v_add_u32 v49, v49, v6
    v_add_u32 v49, 102400, v49
    v_mul_u32_u24 v25, 12, v49
    v_cmp_lt_u32 s[64:65], v5, v48
    v_cmp_lt_u32 s[66:67], v4, v48
    v_subrev_u32 v48, s6, v48
    v_max_i32 v52, v52, v48

    v_lshrrev_b32 v48, 16, v42
    v_and_b32 v49, 0xffff, v42
    v_add_u32 v49, v49, v6
    v_add_u32 v49, 204800, v49
    v_mul_u32_u24 v26, 12, v49
    v_cmp_lt_u32 s[68:69], v5, v48
    v_cmp_lt_u32 s[70:71], v4, v48
    v_subrev_u32 v48, s6, v48
    v_max_i32 v52, v52, v48

    v_lshrrev_b32 v48, 16, v43
    v_and_b32 v49, 0xffff, v43
    v_add_u32 v49, v49, v6
    v_add_u32 v49, 307200, v49
    v_mul_u32_u24 v27, 12, v49
    v_cmp_lt_u32 s[72:73], v5, v48
    v_cmp_lt_u32 s[74:75], v4, v48
    v_subrev_u32 v48, s6, v48
    v_max_i32 v52, v52, v48

    v_lshrrev_b32 v48, 16, v44
    v_and_b32 v49, 0xffff, v44
    v_add_u32 v49, v49, v6
    v_add_u32 v49, 409600, v49
    v_mul_u32_u24 v28, 12, v49
    v_cmp_lt_u32 s[76:77], v5, v48
    v_cmp_lt_u32 s[78:79], v4, v48
    v_subrev_u32 v48, s6, v48
    v_max_i32 v52, v52, v48

    v_lshrrev_b32 v48, 16, v45
    v_and_b32 v49, 0xffff, v45
    v_add_u32 v49, v49, v6
    v_add_u32 v49, 512000, v49
    v_mul_u32_u24 v29, 12, v49
    v_cmp_lt_u32 s[80:81], v5, v48
    v_cmp_lt_u32 s[82:83], v4, v48
    v_subrev_u32 v48, s6, v48
    v_max_i32 v52, v52, v48

    v_lshrrev_b32 v48, 16, v46
    v_and_b32 v49, 0xffff, v46
    v_add_u32 v49, v49, v6
    v_add_u32 v49, 614400, v49
    v_mul_u32_u24 v30, 12, v49
    v_cmp_lt_u32 s[84:85], v5, v48
    v_cmp_lt_u32 s[86:87], v4, v48
    v_subrev_u32 v48, s6, v48
    v_max_i32 v52, v52, v48

    v_lshrrev_b32 v48, 16, v47
    v_and_b32 v49, 0xffff, v47
    v_add_u32 v49, v49, v6
    v_add_u32 v49, 716800, v49
    v_mul_u32_u24 v31, 12, v49
    v_cmp_lt_u32 s[88:89], v5, v48
    v_cmp_lt_u32 s[90:91], v4, v48
    v_subrev_u32 v48, s6, v48
    v_max_i32 v52, v52, v48

    v_cndmask_b32 v50, v7, v24, s[62:63]
    buffer_load_dwordx3 v[116:118], v50, s[44:47], 0 offen offset:192

    v_cndmask_b32 v50, v7, v25, s[66:67]
    buffer_load_dwordx3 v[124:126], v50, s[44:47], 0 offen offset:192

    v_cndmask_b32 v50, v7, v26, s[70:71]
    buffer_load_dwordx3 v[132:134], v50, s[44:47], 0 offen offset:192

    v_cndmask_b32 v50, v7, v27, s[74:75]
    buffer_load_dwordx3 v[140:142], v50, s[44:47], 0 offen offset:192

    v_cndmask_b32 v50, v7, v28, s[78:79]
    buffer_load_dwordx3 v[148:150], v50, s[44:47], 0 offen offset:192

    v_cndmask_b32 v50, v7, v29, s[82:83]
    buffer_load_dwordx3 v[156:158], v50, s[44:47], 0 offen offset:192

    v_cndmask_b32 v50, v7, v30, s[86:87]
    buffer_load_dwordx3 v[164:166], v50, s[44:47], 0 offen offset:192

    v_cndmask_b32 v50, v7, v31, s[90:91]
    buffer_load_dwordx3 v[172:174], v50, s[44:47], 0 offen offset:192

    v_cndmask_b32 v50, v7, v24, s[60:61]
    buffer_load_dwordx3 v[112:114], v50, s[44:47], 0 offen

    v_cndmask_b32 v50, v7, v25, s[64:65]
    buffer_load_dwordx3 v[120:122], v50, s[44:47], 0 offen

    v_cndmask_b32 v50, v7, v26, s[68:69]
    buffer_load_dwordx3 v[128:130], v50, s[44:47], 0 offen

    v_cndmask_b32 v50, v7, v27, s[72:73]
    buffer_load_dwordx3 v[136:138], v50, s[44:47], 0 offen

    v_cndmask_b32 v50, v7, v28, s[76:77]
    buffer_load_dwordx3 v[144:146], v50, s[44:47], 0 offen

    v_cndmask_b32 v50, v7, v29, s[80:81]
    buffer_load_dwordx3 v[152:154], v50, s[44:47], 0 offen

    v_cndmask_b32 v50, v7, v30, s[84:85]
    buffer_load_dwordx3 v[160:162], v50, s[44:47], 0 offen

    v_cndmask_b32 v50, v7, v31, s[88:89]
    buffer_load_dwordx3 v[168:170], v50, s[44:47], 0 offen

    s_waitcnt vmcnt(16)
    s_barrier
    v_add_u32 v54, 130064, v53

    s_cmp_ge_u32 s3, 7
    s_cbranch_scc1 K2_NOA1
    v_and_b32 v55, 31, v1
    v_lshrrev_b32 v56, 4, v55
    v_lshlrev_b32 v56, 3, v56
    v_bfe_u32 v57, v55, 3, 1
    v_lshl_add_u32 v56, v57, 2, v56
    v_and_b32 v57, 3, v55
    v_add_u32 v56, v56, v57
    v_lshrrev_b32 v57, 1, v56
    v_lshrrev_b32 v58, 5, v1
    v_xor_b32 v57, v57, v58
    v_lshlrev_b32 v57, 4, v57
    v_lshl_add_u32 v56, v56, 7, v57
    s_lshl_b32 s19, s3, 11
    s_add_u32 s19, s19, 148496

    v_xor_b32 v57, 0, v56
    v_add_u32 v57, s19, v57
    ds_read_b128 v[8:11], v57

    v_xor_b32 v57, 32, v56
    v_add_u32 v57, s19, v57
    ds_read_b128 v[12:15], v57

    v_xor_b32 v57, 64, v56
    v_add_u32 v57, s19, v57
    ds_read_b128 v[16:19], v57

    v_xor_b32 v57, 96, v56
    v_add_u32 v57, s19, v57
    ds_read_b128 v[20:23], v57

    ds_read_b128 v[176:179], v54 offset:10240
    ds_read_b128 v[180:183], v54 offset:11264
    ds_read_b128 v[184:187], v54 offset:12288
    ds_read_b128 v[188:191], v54 offset:13312
    ds_read_b128 v[192:195], v54 offset:14336
    ds_read_b128 v[196:199], v54 offset:15360
    ds_read_b128 v[200:203], v54 offset:16384
    ds_read_b128 v[204:207], v54 offset:17408
K2_NOA1:
    ds_read_b128 v[96:99], v54 offset:0
    ds_read_b128 v[100:103], v54 offset:1024
    ds_read_b128 v[64:67], v54 offset:2048
    ds_read_b128 v[68:71], v54 offset:3072
    ds_read_b128 v[72:75], v54 offset:4096
    ds_read_b128 v[76:79], v54 offset:5120
    ds_read_b128 v[80:83], v54 offset:6144
    ds_read_b128 v[84:87], v54 offset:7168
    ds_read_b128 v[88:91], v54 offset:8192
    ds_read_b128 v[92:95], v54 offset:9216
    s_cmp_ge_u32 s3, 7
    s_cbranch_scc1 K2_NOA2
    s_lshl_b32 s19, s3, 12
    s_add_u32 s19, s19, 103440
    v_add_u32 v54, s19, v53
    s_waitcnt lgkmcnt(10)

    v_mfma_f32_32x32x16_bf16 v[24:39], v[8:11], v[176:179], 0
    v_mfma_f32_32x32x16_bf16 v[24:39], v[12:15], v[184:187], v[24:39]
    v_mfma_f32_32x32x16_bf16 v[24:39], v[16:19], v[192:195], v[24:39]
    v_mfma_f32_32x32x16_bf16 v[24:39], v[20:23], v[200:203], v[24:39]
    s_nop 11
    v_cvt_pk_bf16_f32 v40, v24, v25
    v_lshlrev_b32 v48, 16, v40
    v_and_b32 v49, 0xffff0000, v40
    v_sub_f32 v48, v24, v48
    v_sub_f32 v49, v25, v49
    v_cvt_pk_bf16_f32 v48, v48, v49
    v_cndmask_b32 v40, v40, v48, s[10:11]

    v_cvt_pk_bf16_f32 v41, v26, v27
    v_lshlrev_b32 v48, 16, v41
    v_and_b32 v49, 0xffff0000, v41
    v_sub_f32 v48, v26, v48
    v_sub_f32 v49, v27, v49
    v_cvt_pk_bf16_f32 v48, v48, v49
    v_cndmask_b32 v41, v41, v48, s[10:11]

    v_cvt_pk_bf16_f32 v42, v28, v29
    v_lshlrev_b32 v48, 16, v42
    v_and_b32 v49, 0xffff0000, v42
    v_sub_f32 v48, v28, v48
    v_sub_f32 v49, v29, v49
    v_cvt_pk_bf16_f32 v48, v48, v49
    v_cndmask_b32 v42, v42, v48, s[10:11]

    v_cvt_pk_bf16_f32 v43, v30, v31
    v_lshlrev_b32 v48, 16, v43
    v_and_b32 v49, 0xffff0000, v43
    v_sub_f32 v48, v30, v48
    v_sub_f32 v49, v31, v49
    v_cvt_pk_bf16_f32 v48, v48, v49
    v_cndmask_b32 v43, v43, v48, s[10:11]

    v_cvt_pk_bf16_f32 v44, v32, v33
    v_lshlrev_b32 v48, 16, v44
    v_and_b32 v49, 0xffff0000, v44
    v_sub_f32 v48, v32, v48
    v_sub_f32 v49, v33, v49
    v_cvt_pk_bf16_f32 v48, v48, v49
    v_cndmask_b32 v44, v44, v48, s[10:11]

    v_cvt_pk_bf16_f32 v45, v34, v35
    v_lshlrev_b32 v48, 16, v45
    v_and_b32 v49, 0xffff0000, v45
    v_sub_f32 v48, v34, v48
    v_sub_f32 v49, v35, v49
    v_cvt_pk_bf16_f32 v48, v48, v49
    v_cndmask_b32 v45, v45, v48, s[10:11]

    v_cvt_pk_bf16_f32 v46, v36, v37
    v_lshlrev_b32 v48, 16, v46
    v_and_b32 v49, 0xffff0000, v46
    v_sub_f32 v48, v36, v48
    v_sub_f32 v49, v37, v49
    v_cvt_pk_bf16_f32 v48, v48, v49
    v_cndmask_b32 v46, v46, v48, s[10:11]

    v_cvt_pk_bf16_f32 v47, v38, v39
    v_lshlrev_b32 v48, 16, v47
    v_and_b32 v49, 0xffff0000, v47
    v_sub_f32 v48, v38, v48
    v_sub_f32 v49, v39, v49
    v_cvt_pk_bf16_f32 v48, v48, v49
    v_cndmask_b32 v47, v47, v48, s[10:11]

    v_mfma_f32_32x32x16_bf16 v[24:39], v[8:11], v[180:183], 0
    v_mfma_f32_32x32x16_bf16 v[24:39], v[12:15], v[188:191], v[24:39]
    v_mfma_f32_32x32x16_bf16 v[24:39], v[16:19], v[196:199], v[24:39]
    v_mfma_f32_32x32x16_bf16 v[24:39], v[20:23], v[204:207], v[24:39]
    s_nop 11
    v_cvt_pk_bf16_f32 v104, v24, v25
    v_lshlrev_b32 v48, 16, v104
    v_and_b32 v49, 0xffff0000, v104
    v_sub_f32 v48, v24, v48
    v_sub_f32 v49, v25, v49
    v_cvt_pk_bf16_f32 v48, v48, v49
    v_cndmask_b32 v104, v104, v48, s[10:11]

    v_cvt_pk_bf16_f32 v105, v26, v27
    v_lshlrev_b32 v48, 16, v105
    v_and_b32 v49, 0xffff0000, v105
    v_sub_f32 v48, v26, v48
    v_sub_f32 v49, v27, v49
    v_cvt_pk_bf16_f32 v48, v48, v49
    v_cndmask_b32 v105, v105, v48, s[10:11]

    v_cvt_pk_bf16_f32 v106, v28, v29
    v_lshlrev_b32 v48, 16, v106
    v_and_b32 v49, 0xffff0000, v106
    v_sub_f32 v48, v28, v48
    v_sub_f32 v49, v29, v49
    v_cvt_pk_bf16_f32 v48, v48, v49
    v_cndmask_b32 v106, v106, v48, s[10:11]

    v_cvt_pk_bf16_f32 v107, v30, v31
    v_lshlrev_b32 v48, 16, v107
    v_and_b32 v49, 0xffff0000, v107
    v_sub_f32 v48, v30, v48
    v_sub_f32 v49, v31, v49
    v_cvt_pk_bf16_f32 v48, v48, v49
    v_cndmask_b32 v107, v107, v48, s[10:11]

    v_cvt_pk_bf16_f32 v108, v32, v33
    v_lshlrev_b32 v48, 16, v108
    v_and_b32 v49, 0xffff0000, v108
    v_sub_f32 v48, v32, v48
    v_sub_f32 v49, v33, v49
    v_cvt_pk_bf16_f32 v48, v48, v49
    v_cndmask_b32 v108, v108, v48, s[10:11]

    v_cvt_pk_bf16_f32 v109, v34, v35
    v_lshlrev_b32 v48, 16, v109
    v_and_b32 v49, 0xffff0000, v109
    v_sub_f32 v48, v34, v48
    v_sub_f32 v49, v35, v49
    v_cvt_pk_bf16_f32 v48, v48, v49
    v_cndmask_b32 v109, v109, v48, s[10:11]

    v_cvt_pk_bf16_f32 v110, v36, v37
    v_lshlrev_b32 v48, 16, v110
    v_and_b32 v49, 0xffff0000, v110
    v_sub_f32 v48, v36, v48
    v_sub_f32 v49, v37, v49
    v_cvt_pk_bf16_f32 v48, v48, v49
    v_cndmask_b32 v110, v110, v48, s[10:11]

    v_cvt_pk_bf16_f32 v111, v38, v39
    v_lshlrev_b32 v48, 16, v111
    v_and_b32 v49, 0xffff0000, v111
    v_sub_f32 v48, v38, v48
    v_sub_f32 v49, v39, v49
    v_cvt_pk_bf16_f32 v48, v48, v49
    v_cndmask_b32 v111, v111, v48, s[10:11]

    ds_write_b128 v54, v[40:43]
    ds_write_b128 v54, v[104:107] offset:1024
    s_cmp_eq_u32 s3, 6
    s_cbranch_scc1 K2_NOA2
    ds_write_b128 v54, v[44:47] offset:2048
    ds_write_b128 v54, v[108:111] offset:3072
K2_NOA2:

    v_mov_b64 v[56:57], 0
    v_mov_b64 v[58:59], 0
    v_lshlrev_b32 v54, 4, v0
    v_add_u32 v54, 57104, v54

    ds_write_b128 v54, v[56:59] offset:0
    ds_write_b128 v54, v[56:59] offset:8192
    ds_write_b128 v54, v[56:59] offset:16384
    ds_write_b128 v54, v[56:59] offset:24576
    ds_write_b128 v54, v[56:59] offset:32768
    v_cmp_gt_u32 vcc, 336, v0
    s_and_saveexec_b64 s[96:97], vcc
    ds_write_b128 v54, v[56:59] offset:40960
    s_mov_b64 exec, s[96:97]

    v_lshlrev_b32 v62, 16, v62
    v_lshlrev_b32 v54, 2, v0
    v_cmp_gt_u32 vcc, 64, v0
    s_and_saveexec_b64 s[96:97], vcc
    ds_write_b32 v54, v62 offset:128
    s_mov_b64 exec, s[96:97]
    v_lshlrev_b32 v54, 4, v0
    v_cmp_gt_u32 vcc, 104, v0
    s_and_saveexec_b64 s[96:97], vcc
    ds_write_b128 v54, v[240:243] offset:384
    s_mov_b64 exec, s[96:97]

    v_and_b32 v54, 7, v1
    v_lshrrev_b32 v55, 4, v1
    v_xor_b32 v63, v54, v55
    v_lshlrev_b32 v233, 4, v63
    v_xor_b32 v235, 64, v233
    v_mov_b32 v237, v233
    v_mov_b32 v239, v235
    v_and_b32 v54, 31, v1
    v_lshrrev_b32 v55, 5, v1
    v_bfe_u32 v63, v54, 1, 3
    v_xor_b32 v63, v63, v55
    v_lshlrev_b32 v63, 4, v63
    v_lshl_add_u32 v63, v54, 7, v63
    v_add_u32 v208, s5, v63
    v_xor_b32 v61, 32, v63
    v_add_u32 v209, s5, v61
    v_xor_b32 v61, 64, v63
    v_add_u32 v210, s5, v61
    v_xor_b32 v61, 96, v63
    v_add_u32 v211, s5, v61
    v_bfe_u32 v63, v1, 2, 2
    v_lshl_add_u32 v63, v55, 2, v63
    v_lshlrev_b32 v63, 6, v63
    v_bfe_u32 v61, v1, 4, 1
    v_lshl_add_u32 v63, v61, 5, v63
    v_and_b32 v61, 3, v1
    v_lshl_add_u32 v63, v61, 3, v63
    v_add_u32 v212, s7, v63
    v_lshlrev_b32 v216, 4, v1
    v_lshrrev_b32 v63, 3, v1
    v_lshlrev_b32 v63, 2, v63
    v_add_u32 v213, 2192, v63
    v_lshlrev_b32 v214, 2, v54
    v_lshl_add_u32 v215, v54, 6, s7
    v_mov_b32 v217, 0
    v_mov_b32 v218, 0
    v_mov_b64 v[220:221], 0

    v_mov_b32 v50, 4
    v_mov_b32 v51, 2112
    v_mov_b32 v48, 1
    v_cmp_lt_i32 vcc, 32, v52
    s_and_saveexec_b64 s[96:97], vcc
    ds_write_b32 v51, v48 offset:4
    s_mov_b64 exec, -1
    s_waitcnt vmcnt(8)

    s_mov_b64 exec, s[62:63]
    s_cbranch_execz K2_RKo_1
    v_lshrrev_b32 v49, 21, v118
    v_and_b32 v49, 60, v49
    ds_add_rtn_u32 v193, v49, v50 offset:2048
K2_RKo_1:

    s_mov_b64 exec, s[66:67]
    s_cbranch_execz K2_RKo_3
    v_lshrrev_b32 v49, 21, v126
    v_and_b32 v49, 60, v49
    ds_add_rtn_u32 v195, v49, v50 offset:2048
K2_RKo_3:

    s_mov_b64 exec, s[70:71]
    s_cbranch_execz K2_RKo_5
    v_lshrrev_b32 v49, 21, v134
    v_and_b32 v49, 60, v49
    ds_add_rtn_u32 v197, v49, v50 offset:2048
K2_RKo_5:

    s_mov_b64 exec, s[74:75]
    s_cbranch_execz K2_RKo_7
    v_lshrrev_b32 v49, 21, v142
    v_and_b32 v49, 60, v49
    ds_add_rtn_u32 v199, v49, v50 offset:2048
K2_RKo_7:

    s_mov_b64 exec, s[78:79]
    s_cbranch_execz K2_RKo_9
    v_lshrrev_b32 v49, 21, v150
    v_and_b32 v49, 60, v49
    ds_add_rtn_u32 v201, v49, v50 offset:2048
K2_RKo_9:

    s_mov_b64 exec, s[82:83]
    s_cbranch_execz K2_RKo_11
    v_lshrrev_b32 v49, 21, v158
    v_and_b32 v49, 60, v49
    ds_add_rtn_u32 v203, v49, v50 offset:2048
K2_RKo_11:

    s_mov_b64 exec, s[86:87]
    s_cbranch_execz K2_RKo_13
    v_lshrrev_b32 v49, 21, v166
    v_and_b32 v49, 60, v49
    ds_add_rtn_u32 v205, v49, v50 offset:2048
K2_RKo_13:

    s_mov_b64 exec, s[90:91]
    s_cbranch_execz K2_RKo_15
    v_lshrrev_b32 v49, 21, v174
    v_and_b32 v49, 60, v49
    ds_add_rtn_u32 v207, v49, v50 offset:2048
K2_RKo_15:

    s_mov_b64 exec, s[60:61]
    s_waitcnt vmcnt(7)
    v_lshrrev_b32 v49, 21, v114
    v_and_b32 v49, 60, v49
    ds_add_rtn_u32 v192, v49, v50 offset:2048

    s_mov_b64 exec, s[64:65]
    s_waitcnt vmcnt(6)
    v_lshrrev_b32 v49, 21, v122
    v_and_b32 v49, 60, v49
    ds_add_rtn_u32 v194, v49, v50 offset:2048

    s_mov_b64 exec, s[68:69]
    s_waitcnt vmcnt(5)
    v_lshrrev_b32 v49, 21, v130
    v_and_b32 v49, 60, v49
    ds_add_rtn_u32 v196, v49, v50 offset:2048

    s_mov_b64 exec, s[72:73]
    s_waitcnt vmcnt(4)
    v_lshrrev_b32 v49, 21, v138
    v_and_b32 v49, 60, v49
    ds_add_rtn_u32 v198, v49, v50 offset:2048

    s_mov_b64 exec, s[76:77]
    s_waitcnt vmcnt(3)
    v_lshrrev_b32 v49, 21, v146
    v_and_b32 v49, 60, v49
    ds_add_rtn_u32 v200, v49, v50 offset:2048

    s_mov_b64 exec, s[80:81]
    s_waitcnt vmcnt(2)
    v_lshrrev_b32 v49, 21, v154
    v_and_b32 v49, 60, v49
    ds_add_rtn_u32 v202, v49, v50 offset:2048

    s_mov_b64 exec, s[84:85]
    s_waitcnt vmcnt(1)
    v_lshrrev_b32 v49, 21, v162
    v_and_b32 v49, 60, v49
    ds_add_rtn_u32 v204, v49, v50 offset:2048

    s_mov_b64 exec, s[88:89]
    s_waitcnt vmcnt(0)
    v_lshrrev_b32 v49, 21, v170
    v_and_b32 v49, 60, v49
    ds_add_rtn_u32 v206, v49, v50 offset:2048

    s_waitcnt lgkmcnt(0)
    s_mov_b64 exec, s[62:63]
    s_cbranch_execz K2_PLo_1

    v_min_u32 v49, 18300, v193
    v_lshlrev_b32 v48, 1, v49
    ds_write_b32 v49, v118 offset:2192
    ds_write_b64 v48, v[116:117] offset:20496

K2_PLo_1:
    s_mov_b64 exec, s[66:67]
    s_cbranch_execz K2_PLo_3

    v_min_u32 v49, 18300, v195
    v_lshlrev_b32 v48, 1, v49
    ds_write_b32 v49, v126 offset:2192
    ds_write_b64 v48, v[124:125] offset:20496

K2_PLo_3:
    s_mov_b64 exec, s[70:71]
    s_cbranch_execz K2_PLo_5

    v_min_u32 v49, 18300, v197
    v_lshlrev_b32 v48, 1, v49
    ds_write_b32 v49, v134 offset:2192
    ds_write_b64 v48, v[132:133] offset:20496

K2_PLo_5:
    s_mov_b64 exec, s[74:75]
    s_cbranch_execz K2_PLo_7

    v_min_u32 v49, 18300, v199
    v_lshlrev_b32 v48, 1, v49
    ds_write_b32 v49, v142 offset:2192
    ds_write_b64 v48, v[140:141] offset:20496

K2_PLo_7:
    s_mov_b64 exec, s[78:79]
    s_cbranch_execz K2_PLo_9

    v_min_u32 v49, 18300, v201
    v_lshlrev_b32 v48, 1, v49
    ds_write_b32 v49, v150 offset:2192
    ds_write_b64 v48, v[148:149] offset:20496

K2_PLo_9:
    s_mov_b64 exec, s[82:83]
    s_cbranch_execz K2_PLo_11

    v_min_u32 v49, 18300, v203
    v_lshlrev_b32 v48, 1, v49
    ds_write_b32 v49, v158 offset:2192
    ds_write_b64 v48, v[156:157] offset:20496

K2_PLo_11:
    s_mov_b64 exec, s[86:87]
    s_cbranch_execz K2_PLo_13

    v_min_u32 v49, 18300, v205
    v_lshlrev_b32 v48, 1, v49
    ds_write_b32 v49, v166 offset:2192
    ds_write_b64 v48, v[164:165] offset:20496

K2_PLo_13:
    s_mov_b64 exec, s[90:91]
    s_cbranch_execz K2_PLo_15

    v_min_u32 v49, 18300, v207
    v_lshlrev_b32 v48, 1, v49
    ds_write_b32 v49, v174 offset:2192
    ds_write_b64 v48, v[172:173] offset:20496

K2_PLo_15:
    s_mov_b64 exec, s[60:61]
    v_min_u32 v49, 18300, v192
    v_lshlrev_b32 v48, 1, v49
    ds_write_b32 v49, v114 offset:2192
    ds_write_b64 v48, v[112:113] offset:20496

    s_mov_b64 exec, s[64:65]
    v_min_u32 v49, 18300, v194
    v_lshlrev_b32 v48, 1, v49
    ds_write_b32 v49, v122 offset:2192
    ds_write_b64 v48, v[120:121] offset:20496

    s_mov_b64 exec, s[68:69]
    v_min_u32 v49, 18300, v196
    v_lshlrev_b32 v48, 1, v49
    ds_write_b32 v49, v130 offset:2192
    ds_write_b64 v48, v[128:129] offset:20496

    s_mov_b64 exec, s[72:73]
    v_min_u32 v49, 18300, v198
    v_lshlrev_b32 v48, 1, v49
    ds_write_b32 v49, v138 offset:2192
    ds_write_b64 v48, v[136:137] offset:20496

    s_mov_b64 exec, s[76:77]
    v_min_u32 v49, 18300, v200
    v_lshlrev_b32 v48, 1, v49
    ds_write_b32 v49, v146 offset:2192
    ds_write_b64 v48, v[144:145] offset:20496

    s_mov_b64 exec, s[80:81]
    v_min_u32 v49, 18300, v202
    v_lshlrev_b32 v48, 1, v49
    ds_write_b32 v49, v154 offset:2192
    ds_write_b64 v48, v[152:153] offset:20496

    s_mov_b64 exec, s[84:85]
    v_min_u32 v49, 18300, v204
    v_lshlrev_b32 v48, 1, v49
    ds_write_b32 v49, v162 offset:2192
    ds_write_b64 v48, v[160:161] offset:20496

    s_mov_b64 exec, s[88:89]
    v_min_u32 v49, 18300, v206
    v_lshlrev_b32 v48, 1, v49
    ds_write_b32 v49, v170 offset:2192
    ds_write_b64 v48, v[168:169] offset:20496

    s_mov_b64 exec, -1
    v_lshlrev_b32 v2, 2, v1
    v_mul_u32_u24 v4, 1408, v1
    s_waitcnt lgkmcnt(0)
    s_barrier
    ds_read_b32 v3, v2 offset:2048

    v_mov_b64 v[32:33], 0
    v_mov_b64 v[34:35], 0
    v_mov_b64 v[36:37], 0
    v_mov_b64 v[38:39], 0
    v_mov_b64 v[40:41], 0
    v_mov_b64 v[42:43], 0
    v_mov_b64 v[44:45], 0
    v_mov_b64 v[46:47], 0
    v_mov_b64 v[48:49], 0
    v_mov_b64 v[50:51], 0
    v_mov_b64 v[52:53], 0
    v_mov_b64 v[54:55], 0
    v_mov_b64 v[56:57], 0
    v_mov_b64 v[58:59], 0
    v_mov_b64 v[60:61], 0
    v_mov_b64 v[62:63], 0
    v_mov_b64 v[136:137], 0
    v_mov_b64 v[138:139], 0
    v_mov_b64 v[140:141], 0
    v_mov_b64 v[142:143], 0
    v_mov_b64 v[152:153], 0
    v_mov_b64 v[154:155], 0
    v_mov_b64 v[156:157], 0
    v_mov_b64 v[158:159], 0
    v_mov_b64 v[132:133], 0
    v_mov_b64 v[134:135], 0
    v_cmp_gt_u32 vcc, 13, v1
    s_waitcnt lgkmcnt(0)
    v_sub_u32 v3, v3, v4
    v_lshrrev_b32 v3, 2, v3
    v_cndmask_b32 v3, 0, v3, vcc
    v_cmp_lt_u32 vcc, 352, v3
    s_nop 1
    s_cbranch_vccz K2_COUNTED
    s_barrier
    s_branch K2_SAMEJ

K2_ROUND:
    v_mbcnt_lo_u32_b32 v1, -1, 0
    v_mbcnt_hi_u32_b32 v1, -1, v1
    s_lshl_b32 s19, s3, 6
    v_add_u32 v0, s19, v1

    v_bfe_u32 v2, v1, 3, 2
    v_and_b32 v3, 7, v1
    v_lshl_add_u32 v2, v3, 5, v2
    s_lshl_b32 s19, s3, 12
    s_lshl_b32 s20, s2, 2
    s_add_u32 s19, s19, s20
    v_lshl_add_u32 v3, v2, 10, s19
    buffer_load_dword v39, v3, s[48:51], 0 offen
    v_lshrrev_b32 v2, 4, v0
    v_and_b32 v5, 15, v0
    v_add_u32 v5, s6, v5
    v_add_u32 v4, 16, v5
    v_mul_u32_u24 v6, 3200, v2
    v_add_u32 v6, v6, v5
    v_mov_b32 v7, 0x80000000
    v_mov_b32 v52, 0
    v_lshrrev_b32 v38, 4, v1
    v_lshlrev_b32 v38, 5, v38

    s_waitcnt vmcnt(0) lgkmcnt(0)
    s_barrier

    ds_bpermute_b32 v40, v38, v39 offset:0
    ds_bpermute_b32 v41, v38, v39 offset:4
    ds_bpermute_b32 v42, v38, v39 offset:8
    ds_bpermute_b32 v43, v38, v39 offset:12
    ds_bpermute_b32 v44, v38, v39 offset:16
    ds_bpermute_b32 v45, v38, v39 offset:20
    ds_bpermute_b32 v46, v38, v39 offset:24
    ds_bpermute_b32 v47, v38, v39 offset:28
    s_waitcnt lgkmcnt(0)
    v_lshrrev_b32 v48, 16, v40
    v_and_b32 v49, 0xffff, v40
    v_add_u32 v49, v49, v6
    v_add_u32 v49, 0, v49
    v_mul_u32_u24 v24, 12, v49
    v_cmp_lt_u32 s[60:61], v5, v48
    v_cmp_lt_u32 s[62:63], v4, v48
    v_subrev_u32 v48, s6, v48
    v_max_i32 v52, v52, v48

    v_and_b32 v50, 1, v225
    v_cmp_eq_u32 vcc, 0, v50
    s_and_b64 s[60:61], s[60:61], vcc

    v_and_b32 v50, 2, v225
    v_cmp_eq_u32 vcc, 0, v50
    s_and_b64 s[62:63], s[62:63], vcc

    v_lshrrev_b32 v48, 16, v41
    v_and_b32 v49, 0xffff, v41
    v_add_u32 v49, v49, v6
    v_add_u32 v49, 102400, v49
    v_mul_u32_u24 v25, 12, v49
    v_cmp_lt_u32 s[64:65], v5, v48
    v_cmp_lt_u32 s[66:67], v4, v48
    v_subrev_u32 v48, s6, v48
    v_max_i32 v52, v52, v48

    v_and_b32 v50, 4, v225
    v_cmp_eq_u32 vcc, 0, v50
    s_and_b64 s[64:65], s[64:65], vcc

    v_and_b32 v50, 8, v225
    v_cmp_eq_u32 vcc, 0, v50
    s_and_b64 s[66:67], s[66:67], vcc

    v_lshrrev_b32 v48, 16, v42
    v_and_b32 v49, 0xffff, v42
    v_add_u32 v49, v49, v6
    v_add_u32 v49, 204800, v49
    v_mul_u32_u24 v26, 12, v49
    v_cmp_lt_u32 s[68:69], v5, v48
    v_cmp_lt_u32 s[70:71], v4, v48
    v_subrev_u32 v48, s6, v48
    v_max_i32 v52, v52, v48

    v_and_b32 v50, 16, v225
    v_cmp_eq_u32 vcc, 0, v50
    s_and_b64 s[68:69], s[68:69], vcc

    v_and_b32 v50, 32, v225
    v_cmp_eq_u32 vcc, 0, v50
    s_and_b64 s[70:71], s[70:71], vcc

    v_lshrrev_b32 v48, 16, v43
    v_and_b32 v49, 0xffff, v43
    v_add_u32 v49, v49, v6
    v_add_u32 v49, 307200, v49
    v_mul_u32_u24 v27, 12, v49
    v_cmp_lt_u32 s[72:73], v5, v48
    v_cmp_lt_u32 s[74:75], v4, v48
    v_subrev_u32 v48, s6, v48
    v_max_i32 v52, v52, v48

    v_and_b32 v50, 64, v225
    v_cmp_eq_u32 vcc, 0, v50
    s_and_b64 s[72:73], s[72:73], vcc

    v_and_b32 v50, 128, v225
    v_cmp_eq_u32 vcc, 0, v50
    s_and_b64 s[74:75], s[74:75], vcc

    v_lshrrev_b32 v48, 16, v44
    v_and_b32 v49, 0xffff, v44
    v_add_u32 v49, v49, v6
    v_add_u32 v49, 409600, v49
    v_mul_u32_u24 v28, 12, v49
    v_cmp_lt_u32 s[76:77], v5, v48
    v_cmp_lt_u32 s[78:79], v4, v48
    v_subrev_u32 v48, s6, v48
    v_max_i32 v52, v52, v48

    v_and_b32 v50, 256, v225
    v_cmp_eq_u32 vcc, 0, v50
    s_and_b64 s[76:77], s[76:77], vcc

    v_and_b32 v50, 512, v225
    v_cmp_eq_u32 vcc, 0, v50
    s_and_b64 s[78:79], s[78:79], vcc

    v_lshrrev_b32 v48, 16, v45
    v_and_b32 v49, 0xffff, v45
    v_add_u32 v49, v49, v6
    v_add_u32 v49, 512000, v49
    v_mul_u32_u24 v29, 12, v49
    v_cmp_lt_u32 s[80:81], v5, v48
    v_cmp_lt_u32 s[82:83], v4, v48
    v_subrev_u32 v48, s6, v48
    v_max_i32 v52, v52, v48

    v_and_b32 v50, 1024, v225
    v_cmp_eq_u32 vcc, 0, v50
    s_and_b64 s[80:81], s[80:81], vcc

    v_and_b32 v50, 2048, v225
    v_cmp_eq_u32 vcc, 0, v50
    s_and_b64 s[82:83], s[82:83], vcc

    v_lshrrev_b32 v48, 16, v46
    v_and_b32 v49, 0xffff, v46
    v_add_u32 v49, v49, v6
    v_add_u32 v49, 614400, v49
    v_mul_u32_u24 v30, 12, v49
    v_cmp_lt_u32 s[84:85], v5, v48
    v_cmp_lt_u32 s[86:87], v4, v48
    v_subrev_u32 v48, s6, v48
    v_max_i32 v52, v52, v48

    v_and_b32 v50, 4096, v225
    v_cmp_eq_u32 vcc, 0, v50
    s_and_b64 s[84:85], s[84:85], vcc

    v_and_b32 v50, 8192, v225
    v_cmp_eq_u32 vcc, 0, v50
    s_and_b64 s[86:87], s[86:87], vcc

    v_lshrrev_b32 v48, 16, v47
    v_and_b32 v49, 0xffff, v47
    v_add_u32 v49, v49, v6
    v_add_u32 v49, 716800, v49
    v_mul_u32_u24 v31, 12, v49
    v_cmp_lt_u32 s[88:89], v5, v48
    v_cmp_lt_u32 s[90:91], v4, v48
    v_subrev_u32 v48, s6, v48
    v_max_i32 v52, v52, v48

    v_and_b32 v50, 16384, v225
    v_cmp_eq_u32 vcc, 0, v50
    s_and_b64 s[88:89], s[88:89], vcc

    v_and_b32 v50, 32768, v225
    v_cmp_eq_u32 vcc, 0, v50
    s_and_b64 s[90:91], s[90:91], vcc

    v_cndmask_b32 v50, v7, v24, s[62:63]
    buffer_load_dwordx3 v[116:118], v50, s[44:47], 0 offen offset:192

    v_cndmask_b32 v50, v7, v25, s[66:67]
    buffer_load_dwordx3 v[124:126], v50, s[44:47], 0 offen offset:192

    v_cndmask_b32 v50, v7, v26, s[70:71]
    buffer_load_dwordx3 v[132:134], v50, s[44:47], 0 offen offset:192

    v_cndmask_b32 v50, v7, v27, s[74:75]
    buffer_load_dwordx3 v[140:142], v50, s[44:47], 0 offen offset:192

    v_cndmask_b32 v50, v7, v28, s[78:79]
    buffer_load_dwordx3 v[148:150], v50, s[44:47], 0 offen offset:192

    v_cndmask_b32 v50, v7, v29, s[82:83]
    buffer_load_dwordx3 v[156:158], v50, s[44:47], 0 offen offset:192

    v_cndmask_b32 v50, v7, v30, s[86:87]
    buffer_load_dwordx3 v[164:166], v50, s[44:47], 0 offen offset:192

    v_cndmask_b32 v50, v7, v31, s[90:91]
    buffer_load_dwordx3 v[172:174], v50, s[44:47], 0 offen offset:192

    v_cndmask_b32 v50, v7, v24, s[60:61]
    buffer_load_dwordx3 v[112:114], v50, s[44:47], 0 offen

    v_cndmask_b32 v50, v7, v25, s[64:65]
    buffer_load_dwordx3 v[120:122], v50, s[44:47], 0 offen

    v_cndmask_b32 v50, v7, v26, s[68:69]
    buffer_load_dwordx3 v[128:130], v50, s[44:47], 0 offen

    v_cndmask_b32 v50, v7, v27, s[72:73]
    buffer_load_dwordx3 v[136:138], v50, s[44:47], 0 offen

    v_cndmask_b32 v50, v7, v28, s[76:77]
    buffer_load_dwordx3 v[144:146], v50, s[44:47], 0 offen

    v_cndmask_b32 v50, v7, v29, s[80:81]
    buffer_load_dwordx3 v[152:154], v50, s[44:47], 0 offen

    v_cndmask_b32 v50, v7, v30, s[84:85]
    buffer_load_dwordx3 v[160:162], v50, s[44:47], 0 offen

    v_cndmask_b32 v50, v7, v31, s[88:89]
    buffer_load_dwordx3 v[168:170], v50, s[44:47], 0 offen

    v_and_b32 v54, 7, v1
    v_lshrrev_b32 v55, 4, v1
    v_xor_b32 v63, v54, v55
    v_lshlrev_b32 v233, 4, v63
    v_xor_b32 v235, 64, v233
    v_mov_b32 v237, v233
    v_mov_b32 v239, v235
    v_and_b32 v54, 31, v1
    v_lshrrev_b32 v55, 5, v1
    v_bfe_u32 v63, v54, 1, 3
    v_xor_b32 v63, v63, v55
    v_lshlrev_b32 v63, 4, v63
    v_lshl_add_u32 v63, v54, 7, v63
    v_add_u32 v208, s5, v63
    v_xor_b32 v61, 32, v63
    v_add_u32 v209, s5, v61
    v_xor_b32 v61, 64, v63
    v_add_u32 v210, s5, v61
    v_xor_b32 v61, 96, v63
    v_add_u32 v211, s5, v61
    v_bfe_u32 v63, v1, 2, 2
    v_lshl_add_u32 v63, v55, 2, v63
    v_lshlrev_b32 v63, 6, v63
    v_bfe_u32 v61, v1, 4, 1
    v_lshl_add_u32 v63, v61, 5, v63
    v_and_b32 v61, 3, v1
    v_lshl_add_u32 v63, v61, 3, v63
    v_add_u32 v212, s7, v63
    v_lshlrev_b32 v216, 4, v1
    v_lshrrev_b32 v63, 3, v1
    v_lshlrev_b32 v63, 2, v63
    v_add_u32 v213, 2192, v63
    v_lshlrev_b32 v214, 2, v54
    v_lshl_add_u32 v215, v54, 6, s7
    v_mov_b32 v217, 0
    v_mov_b32 v218, 0
    v_mov_b64 v[220:221], 0

    v_mov_b32 v50, 1
    v_mov_b32 v51, 2112
    v_cmp_lt_i32 vcc, 32, v52
    s_and_saveexec_b64 s[96:97], vcc
    ds_write_b32 v51, v50 offset:4
    s_mov_b64 exec, -1
    s_waitcnt vmcnt(8)

    s_mov_b64 exec, s[62:63]
    s_cbranch_execz K2_RKb_1
    v_bfe_u32 v177, v118, 23, 4
    v_lshlrev_b32 v49, 2, v177
    ds_add_rtn_u32 v193, v49, v50 offset:2048
K2_RKb_1:

    s_mov_b64 exec, s[66:67]
    s_cbranch_execz K2_RKb_3
    v_bfe_u32 v179, v126, 23, 4
    v_lshlrev_b32 v49, 2, v179
    ds_add_rtn_u32 v195, v49, v50 offset:2048
K2_RKb_3:

    s_mov_b64 exec, s[70:71]
    s_cbranch_execz K2_RKb_5
    v_bfe_u32 v181, v134, 23, 4
    v_lshlrev_b32 v49, 2, v181
    ds_add_rtn_u32 v197, v49, v50 offset:2048
K2_RKb_5:

    s_mov_b64 exec, s[74:75]
    s_cbranch_execz K2_RKb_7
    v_bfe_u32 v183, v142, 23, 4
    v_lshlrev_b32 v49, 2, v183
    ds_add_rtn_u32 v199, v49, v50 offset:2048
K2_RKb_7:

    s_mov_b64 exec, s[78:79]
    s_cbranch_execz K2_RKb_9
    v_bfe_u32 v185, v150, 23, 4
    v_lshlrev_b32 v49, 2, v185
    ds_add_rtn_u32 v201, v49, v50 offset:2048
K2_RKb_9:

    s_mov_b64 exec, s[82:83]
    s_cbranch_execz K2_RKb_11
    v_bfe_u32 v187, v158, 23, 4
    v_lshlrev_b32 v49, 2, v187
    ds_add_rtn_u32 v203, v49, v50 offset:2048
K2_RKb_11:

    s_mov_b64 exec, s[86:87]
    s_cbranch_execz K2_RKb_13
    v_bfe_u32 v189, v166, 23, 4
    v_lshlrev_b32 v49, 2, v189
    ds_add_rtn_u32 v205, v49, v50 offset:2048
K2_RKb_13:

    s_mov_b64 exec, s[90:91]
    s_cbranch_execz K2_RKb_15
    v_bfe_u32 v191, v174, 23, 4
    v_lshlrev_b32 v49, 2, v191
    ds_add_rtn_u32 v207, v49, v50 offset:2048
K2_RKb_15:

    s_mov_b64 exec, s[60:61]
    s_waitcnt vmcnt(7)
    v_bfe_u32 v176, v114, 23, 4
    v_lshlrev_b32 v49, 2, v176
    ds_add_rtn_u32 v192, v49, v50 offset:2048

    s_mov_b64 exec, s[64:65]
    s_waitcnt vmcnt(6)
    v_bfe_u32 v178, v122, 23, 4
    v_lshlrev_b32 v49, 2, v178
    ds_add_rtn_u32 v194, v49, v50 offset:2048

    s_mov_b64 exec, s[68:69]
    s_waitcnt vmcnt(5)
    v_bfe_u32 v180, v130, 23, 4
    v_lshlrev_b32 v49, 2, v180
    ds_add_rtn_u32 v196, v49, v50 offset:2048

    s_mov_b64 exec, s[72:73]
    s_waitcnt vmcnt(4)
    v_bfe_u32 v182, v138, 23, 4
    v_lshlrev_b32 v49, 2, v182
    ds_add_rtn_u32 v198, v49, v50 offset:2048

    s_mov_b64 exec, s[76:77]
    s_waitcnt vmcnt(3)
    v_bfe_u32 v184, v146, 23, 4
    v_lshlrev_b32 v49, 2, v184
    ds_add_rtn_u32 v200, v49, v50 offset:2048

    s_mov_b64 exec, s[80:81]
    s_waitcnt vmcnt(2)
    v_bfe_u32 v186, v154, 23, 4
    v_lshlrev_b32 v49, 2, v186
    ds_add_rtn_u32 v202, v49, v50 offset:2048

    s_mov_b64 exec, s[84:85]
    s_waitcnt vmcnt(1)
    v_bfe_u32 v188, v162, 23, 4
    v_lshlrev_b32 v49, 2, v188
    ds_add_rtn_u32 v204, v49, v50 offset:2048

    s_mov_b64 exec, s[88:89]
    s_waitcnt vmcnt(0)
    v_bfe_u32 v190, v170, 23, 4
    v_lshlrev_b32 v49, 2, v190
    ds_add_rtn_u32 v206, v49, v50 offset:2048

    s_mov_b64 exec, -1
    s_movk_i32 s19, 352
    s_mov_b64 s[98:99], 0
    s_waitcnt lgkmcnt(0)

    s_mov_b64 exec, s[62:63]
    s_cbranch_execz K2_PLb_1

    v_cmp_gt_u32 vcc, s19, v193
    v_mad_u32_u24 v49, v177, s19, v193
    v_lshlrev_b32 v48, 3, v49
    v_lshlrev_b32 v49, 2, v49
    s_andn2_b64 s[96:97], s[62:63], vcc
    s_and_b64 exec, s[62:63], vcc
    ds_write_b32 v49, v118 offset:2192
    ds_write_b64 v48, v[116:117] offset:20496
    v_or_b32 v225, 2, v225
    s_or_b64 s[98:99], s[98:99], s[96:97]

K2_PLb_1:
    s_mov_b64 exec, s[66:67]
    s_cbranch_execz K2_PLb_3

    v_cmp_gt_u32 vcc, s19, v195
    v_mad_u32_u24 v49, v179, s19, v195
    v_lshlrev_b32 v48, 3, v49
    v_lshlrev_b32 v49, 2, v49
    s_andn2_b64 s[96:97], s[66:67], vcc
    s_and_b64 exec, s[66:67], vcc
    ds_write_b32 v49, v126 offset:2192
    ds_write_b64 v48, v[124:125] offset:20496
    v_or_b32 v225, 8, v225
    s_or_b64 s[98:99], s[98:99], s[96:97]

K2_PLb_3:
    s_mov_b64 exec, s[70:71]
    s_cbranch_execz K2_PLb_5

    v_cmp_gt_u32 vcc, s19, v197
    v_mad_u32_u24 v49, v181, s19, v197
    v_lshlrev_b32 v48, 3, v49
    v_lshlrev_b32 v49, 2, v49
    s_andn2_b64 s[96:97], s[70:71], vcc
    s_and_b64 exec, s[70:71], vcc
    ds_write_b32 v49, v134 offset:2192
    ds_write_b64 v48, v[132:133] offset:20496
    v_or_b32 v225, 32, v225
    s_or_b64 s[98:99], s[98:99], s[96:97]

K2_PLb_5:
    s_mov_b64 exec, s[74:75]
    s_cbranch_execz K2_PLb_7

    v_cmp_gt_u32 vcc, s19, v199
    v_mad_u32_u24 v49, v183, s19, v199
    v_lshlrev_b32 v48, 3, v49
    v_lshlrev_b32 v49, 2, v49
    s_andn2_b64 s[96:97], s[74:75], vcc
    s_and_b64 exec, s[74:75], vcc
    ds_write_b32 v49, v142 offset:2192
    ds_write_b64 v48, v[140:141] offset:20496
    v_or_b32 v225, 128, v225
    s_or_b64 s[98:99], s[98:99], s[96:97]

K2_PLb_7:
    s_mov_b64 exec, s[78:79]
    s_cbranch_execz K2_PLb_9

    v_cmp_gt_u32 vcc, s19, v201
    v_mad_u32_u24 v49, v185, s19, v201
    v_lshlrev_b32 v48, 3, v49
    v_lshlrev_b32 v49, 2, v49
    s_andn2_b64 s[96:97], s[78:79], vcc
    s_and_b64 exec, s[78:79], vcc
    ds_write_b32 v49, v150 offset:2192
    ds_write_b64 v48, v[148:149] offset:20496
    v_or_b32 v225, 512, v225
    s_or_b64 s[98:99], s[98:99], s[96:97]

K2_PLb_9:
    s_mov_b64 exec, s[82:83]
    s_cbranch_execz K2_PLb_11

    v_cmp_gt_u32 vcc, s19, v203
    v_mad_u32_u24 v49, v187, s19, v203
    v_lshlrev_b32 v48, 3, v49
    v_lshlrev_b32 v49, 2, v49
    s_andn2_b64 s[96:97], s[82:83], vcc
    s_and_b64 exec, s[82:83], vcc
    ds_write_b32 v49, v158 offset:2192
    ds_write_b64 v48, v[156:157] offset:20496
    v_or_b32 v225, 2048, v225
    s_or_b64 s[98:99], s[98:99], s[96:97]

K2_PLb_11:
    s_mov_b64 exec, s[86:87]
    s_cbranch_execz K2_PLb_13

    v_cmp_gt_u32 vcc, s19, v205
    v_mad_u32_u24 v49, v189, s19, v205
    v_lshlrev_b32 v48, 3, v49
    v_lshlrev_b32 v49, 2, v49
    s_andn2_b64 s[96:97], s[86:87], vcc
    s_and_b64 exec, s[86:87], vcc
    ds_write_b32 v49, v166 offset:2192
    ds_write_b64 v48, v[164:165] offset:20496
    v_or_b32 v225, 8192, v225
    s_or_b64 s[98:99], s[98:99], s[96:97]

K2_PLb_13:
    s_mov_b64 exec, s[90:91]
    s_cbranch_execz K2_PLb_15

    v_cmp_gt_u32 vcc, s19, v207
    v_mad_u32_u24 v49, v191, s19, v207
    v_lshlrev_b32 v48, 3, v49
    v_lshlrev_b32 v49, 2, v49
    s_andn2_b64 s[96:97], s[90:91], vcc
    s_and_b64 exec, s[90:91], vcc
    ds_write_b32 v49, v174 offset:2192
    ds_write_b64 v48, v[172:173] offset:20496
    v_or_b32 v225, 32768, v225
    s_or_b64 s[98:99], s[98:99], s[96:97]

K2_PLb_15:
    s_mov_b64 exec, -1
    v_cmp_gt_u32 vcc, s19, v192
    v_mad_u32_u24 v49, v176, s19, v192
    v_lshlrev_b32 v48, 3, v49
    v_lshlrev_b32 v49, 2, v49
    s_andn2_b64 s[96:97], s[60:61], vcc
    s_and_b64 exec, s[60:61], vcc
    ds_write_b32 v49, v114 offset:2192
    ds_write_b64 v48, v[112:113] offset:20496
    v_or_b32 v225, 1, v225
    s_or_b64 s[98:99], s[98:99], s[96:97]

    s_mov_b64 exec, -1
    v_cmp_gt_u32 vcc, s19, v194
    v_mad_u32_u24 v49, v178, s19, v194
    v_lshlrev_b32 v48, 3, v49
    v_lshlrev_b32 v49, 2, v49
    s_andn2_b64 s[96:97], s[64:65], vcc
    s_and_b64 exec, s[64:65], vcc
    ds_write_b32 v49, v122 offset:2192
    ds_write_b64 v48, v[120:121] offset:20496
    v_or_b32 v225, 4, v225
    s_or_b64 s[98:99], s[98:99], s[96:97]

    s_mov_b64 exec, -1
    v_cmp_gt_u32 vcc, s19, v196
    v_mad_u32_u24 v49, v180, s19, v196
    v_lshlrev_b32 v48, 3, v49
    v_lshlrev_b32 v49, 2, v49
    s_andn2_b64 s[96:97], s[68:69], vcc
    s_and_b64 exec, s[68:69], vcc
    ds_write_b32 v49, v130 offset:2192
    ds_write_b64 v48, v[128:129] offset:20496
    v_or_b32 v225, 16, v225
    s_or_b64 s[98:99], s[98:99], s[96:97]

    s_mov_b64 exec, -1
    v_cmp_gt_u32 vcc, s19, v198
    v_mad_u32_u24 v49, v182, s19, v198
    v_lshlrev_b32 v48, 3, v49
    v_lshlrev_b32 v49, 2, v49
    s_andn2_b64 s[96:97], s[72:73], vcc
    s_and_b64 exec, s[72:73], vcc
    ds_write_b32 v49, v138 offset:2192
    ds_write_b64 v48, v[136:137] offset:20496
    v_or_b32 v225, 64, v225
    s_or_b64 s[98:99], s[98:99], s[96:97]

    s_mov_b64 exec, -1
    v_cmp_gt_u32 vcc, s19, v200
    v_mad_u32_u24 v49, v184, s19, v200
    v_lshlrev_b32 v48, 3, v49
    v_lshlrev_b32 v49, 2, v49
    s_andn2_b64 s[96:97], s[76:77], vcc
    s_and_b64 exec, s[76:77], vcc
    ds_write_b32 v49, v146 offset:2192
    ds_write_b64 v48, v[144:145] offset:20496
    v_or_b32 v225, 256, v225
    s_or_b64 s[98:99], s[98:99], s[96:97]

    s_mov_b64 exec, -1
    v_cmp_gt_u32 vcc, s19, v202
    v_mad_u32_u24 v49, v186, s19, v202
    v_lshlrev_b32 v48, 3, v49
    v_lshlrev_b32 v49, 2, v49
    s_andn2_b64 s[96:97], s[80:81], vcc
    s_and_b64 exec, s[80:81], vcc
    ds_write_b32 v49, v154 offset:2192
    ds_write_b64 v48, v[152:153] offset:20496
    v_or_b32 v225, 1024, v225
    s_or_b64 s[98:99], s[98:99], s[96:97]

    s_mov_b64 exec, -1
    v_cmp_gt_u32 vcc, s19, v204
    v_mad_u32_u24 v49, v188, s19, v204
    v_lshlrev_b32 v48, 3, v49
    v_lshlrev_b32 v49, 2, v49
    s_andn2_b64 s[96:97], s[84:85], vcc
    s_and_b64 exec, s[84:85], vcc
    ds_write_b32 v49, v162 offset:2192
    ds_write_b64 v48, v[160:161] offset:20496
    v_or_b32 v225, 4096, v225
    s_or_b64 s[98:99], s[98:99], s[96:97]

    s_mov_b64 exec, -1
    v_cmp_gt_u32 vcc, s19, v206
    v_mad_u32_u24 v49, v190, s19, v206
    v_lshlrev_b32 v48, 3, v49
    v_lshlrev_b32 v49, 2, v49
    s_andn2_b64 s[96:97], s[88:89], vcc
    s_and_b64 exec, s[88:89], vcc
    ds_write_b32 v49, v170 offset:2192
    ds_write_b64 v48, v[168:169] offset:20496
    v_or_b32 v225, 16384, v225
    s_or_b64 s[98:99], s[98:99], s[96:97]

    s_mov_b64 exec, s[98:99]
    ds_write_b32 v51, v50
    s_mov_b64 exec, -1

    s_waitcnt vmcnt(0)
K2_PLACED:
    v_lshlrev_b32 v2, 2, v1
    v_cmp_gt_u32 vcc, 13, v1
    s_waitcnt lgkmcnt(0)
    s_barrier
    ds_read_b32 v3, v2 offset:2048

    v_mov_b64 v[32:33], 0
    v_mov_b64 v[34:35], 0
    v_mov_b64 v[36:37], 0
    v_mov_b64 v[38:39], 0
    v_mov_b64 v[40:41], 0
    v_mov_b64 v[42:43], 0
    v_mov_b64 v[44:45], 0
    v_mov_b64 v[46:47], 0
    v_mov_b64 v[48:49], 0
    v_mov_b64 v[50:51], 0
    v_mov_b64 v[52:53], 0
    v_mov_b64 v[54:55], 0
    v_mov_b64 v[56:57], 0
    v_mov_b64 v[58:59], 0
    v_mov_b64 v[60:61], 0
    v_mov_b64 v[62:63], 0
    v_mov_b64 v[136:137], 0
    v_mov_b64 v[138:139], 0
    v_mov_b64 v[140:141], 0
    v_mov_b64 v[142:143], 0
    v_mov_b64 v[152:153], 0
    v_mov_b64 v[154:155], 0
    v_mov_b64 v[156:157], 0
    v_mov_b64 v[158:159], 0
    v_mov_b64 v[132:133], 0
    v_mov_b64 v[134:135], 0
    s_waitcnt lgkmcnt(0)
    v_min_u32 v3, 352, v3
    s_nop 0
    v_cndmask_b32 v3, 0, v3, vcc
K2_COUNTED:
    s_mov_b32 s84, s36
    s_or_b32 s85, s37, 8388608
    s_mov_b32 s86, 25000
    s_mov_b32 s87, 0x20000
    v_add_u32 v4, 31, v3
    v_lshrrev_b32 v4, 5, v4
    v_mov_b32 v5, v4
    s_nop 1
    v_add_u32_dpp v5, v5, v5 row_shr:1 row_mask:0xf bank_mask:0xf bound_ctrl:0
    s_nop 1
    v_add_u32_dpp v5, v5, v5 row_shr:2 row_mask:0xf bank_mask:0xf bound_ctrl:0
    s_nop 1
    v_add_u32_dpp v5, v5, v5 row_shr:4 row_mask:0xf bank_mask:0xf bound_ctrl:0
    s_nop 1
    v_add_u32_dpp v5, v5, v5 row_shr:8 row_mask:0xf bank_mask:0xf bound_ctrl:0
    s_nop 0

    v_readlane_b32 s56, v5, 0
    v_readlane_b32 s57, v5, 1
    v_readlane_b32 s58, v5, 2
    v_readlane_b32 s59, v5, 3
    v_readlane_b32 s60, v5, 4
    v_readlane_b32 s61, v5, 5
    v_readlane_b32 s62, v5, 6
    v_readlane_b32 s63, v5, 7
    v_readlane_b32 s64, v5, 8
    v_readlane_b32 s65, v5, 9
    v_readlane_b32 s66, v5, 10
    v_readlane_b32 s67, v5, 11
    v_readlane_b32 s68, v5, 12
    v_sub_u32 v6, v5, v4
    v_mul_u32_u24 v7, 1408, v1
    v_lshlrev_b32 v8, 7, v6
    v_sub_u32 v7, v7, v8
    v_lshl_add_u32 v8, v6, 5, v3
    s_mul_i32 s20, s68, s3
    s_add_u32 s21, s20, s68
    s_lshr_b32 s20, s20, 3
    s_lshr_b32 s21, s21, 3
    s_sub_u32 s78, s21, s20
    s_mov_b32 s79, 0
    s_mov_b32 s23, -1
    s_cmp_eq_u32 s78, 0
    s_cbranch_scc1 K2_NOCONT
    v_cmp_ge_u32 vcc, s20, v5
    s_and_b32 s21, vcc_lo, 0x1fff
    s_bcnt1_i32_b32 s70, s21
    v_readlane_b32 s21, v6, s70
    v_readlane_b32 s22, v5, s70
    s_nop 3
    s_cmp_lg_u32 s21, s20
    s_cselect_b32 s79, 1, 0
    s_sub_u32 s22, s22, s20
    s_min_u32 s22, s22, s78
    s_mul_i32 s22, s22, s79
    s_sub_u32 s21, s78, s22
    s_sub_u32 s19, s78, 1
    v_min_u32 v9, s19, v1
    v_add_u32 v10, s22, v9
    v_subrev_u32 v11, s21, v9
    v_cmp_gt_u32 vcc, s21, v9
    s_nop 1
    v_cndmask_b32 v9, v11, v10, vcc
    v_add_u32 v9, s20, v9
    v_mov_b32 v10, 0

    v_cmp_le_u32 s[88:89], s56, v9
    v_cmp_le_u32 s[90:91], s57, v9
    v_cmp_le_u32 s[96:97], s58, v9
    v_addc_co_u32 v10, vcc, 0, v10, s[88:89]
    v_cmp_le_u32 s[98:99], s59, v9
    v_addc_co_u32 v10, vcc, 0, v10, s[90:91]
    v_cmp_le_u32 s[88:89], s60, v9
    v_addc_co_u32 v10, vcc, 0, v10, s[96:97]
    v_cmp_le_u32 s[90:91], s61, v9
    v_addc_co_u32 v10, vcc, 0, v10, s[98:99]
    v_cmp_le_u32 s[96:97], s62, v9
    v_addc_co_u32 v10, vcc, 0, v10, s[88:89]
    v_cmp_le_u32 s[98:99], s63, v9
    v_addc_co_u32 v10, vcc, 0, v10, s[90:91]
    v_cmp_le_u32 s[88:89], s64, v9
    v_addc_co_u32 v10, vcc, 0, v10, s[96:97]
    v_cmp_le_u32 s[90:91], s65, v9
    v_addc_co_u32 v10, vcc, 0, v10, s[98:99]
    v_cmp_le_u32 s[96:97], s66, v9
    v_addc_co_u32 v10, vcc, 0, v10, s[88:89]
    v_cmp_le_u32 s[98:99], s67, v9
    v_addc_co_u32 v10, vcc, 0, v10, s[90:91]
    s_nop 0
    v_addc_co_u32 v10, vcc, 0, v10, s[96:97]
    v_addc_co_u32 v10, vcc, 0, v10, s[98:99]
    v_lshlrev_b32 v11, 2, v10
    ds_bpermute_b32 v12, v11, v7
    ds_bpermute_b32 v13, v11, v8
    v_cmp_gt_u32 vcc, s78, v1
    v_lshlrev_b32 v14, 5, v9
    s_waitcnt lgkmcnt(0)
    v_lshl_add_u32 v12, v9, 7, v12
    v_sub_u32 v13, v13, v14
    v_min_u32 v13, 32, v13
    v_cndmask_b32 v13, 0, v13, vcc
    v_lshl_or_b32 v12, v13, 15, v12
    v_lshl_or_b32 v229, v10, 21, v12
    s_mov_b32 s81, 0
    s_nop 0

    v_readlane_b32 s82, v229, s81
    s_add_u32 s81, s81, 1
    s_nop 0
    s_bfe_u32 s19, s82, 0x6000f
    s_and_b32 s73, s82, 0x7fff
    s_bfm_b64 s[76:77], s19, 0
    s_lshr_b32 s12, s82, 21
    s_mov_b32 s77, s76
    v_add_u32 v240, s73, v213
    v_add_u32 v241, s73, v214
    ds_read_u16 v232, v240
    ds_read_u16 v234, v240 offset:32
    ds_read_u16 v236, v240 offset:64
    ds_read_u16 v238, v240 offset:96
    s_mov_b64 exec, s[76:77]
    ds_read_u16 v217, v241 offset:2192
    ds_read_u16 v218, v241 offset:2194
    s_mov_b64 exec, -1

    s_lshl_b32 s19, s12, 11
    s_add_u32 s19, s19, 103440
    v_add_u32 v243, s19, v216
    ds_read_b128 v[104:107], v243
    ds_read_b128 v[108:111], v243 offset:1024

    s_mov_b32 s16, s12
    s_mov_b32 s18, s12
    s_mov_b32 s72, s73
    s_mov_b64 s[74:75], s[76:77]
    s_waitcnt lgkmcnt(0)

    s_mov_b32 m0, s5
    s_nop 0
    buffer_load_dwordx4 v[232:233], s[84:87], 0 idxen offen lds
    s_add_u32 m0, s5, 1024
    s_nop 0
    buffer_load_dwordx4 v[234:235], s[84:87], 0 idxen offen lds
    s_add_u32 m0, s5, 2048
    s_nop 0
    buffer_load_dwordx4 v[236:237], s[84:87], 0 idxen offen lds
    s_add_u32 m0, s5, 3072
    s_nop 0
    buffer_load_dwordx4 v[238:239], s[84:87], 0 idxen offen lds
    buffer_load_dwordx3 v[222:224], v217, s[40:43], 0 idxen
    v_readlane_b32 s82, v229, s81
    s_add_u32 s81, s81, 1
    s_nop 0
    s_bfe_u32 s19, s82, 0x6000f
    s_and_b32 s73, s82, 0x7fff
    s_bfm_b64 s[76:77], s19, 0
    s_lshr_b32 s12, s82, 21
    s_mov_b32 s77, s76
    s_lshl_b32 s20, s72, 1
    s_add_u32 s20, s20, 20496
    v_and_b32 v241, 0x70, v218
    v_lshl_add_u32 v242, v214, 1, s20
    ds_read_b96 v[226:228], v218 offset:384
    ds_read_b128 v[128:131], v241 offset:0
    s_mov_b64 exec, s[74:75]
    ds_read_b64 v[132:133], v242
    s_mov_b64 exec, -1
    v_lshrrev_b32 v241, 1, v241
    v_add_u32 v219, v215, v241
    s_waitcnt vmcnt(0)
    ds_read_b128 v[112:115], v208
    ds_read_b128 v[116:119], v209
    ds_read_b128 v[120:123], v210
    ds_read_b128 v[124:127], v211
    s_waitcnt lgkmcnt(6)
    v_pk_add_f32 v[240:241], v[226:227], v[222:223] neg_lo:[0,1] neg_hi:[0,1]
    v_sub_f32 v242, v228, v224
    v_cvt_pk_bf16_f32 v230, 1.0, v240
    v_cvt_pk_bf16_f32 v231, v241, v242
    v_mul_f32 v240, v240, v240
    v_fmac_f32 v240, v241, v241
    v_fmac_f32 v240, v242, v242
    s_mov_b64 exec, s[74:75]
    ds_write_b64 v219, v[230:231]
    s_mov_b64 exec, -1
    v_cvt_pk_bf16_f32 v134, v240, 0

    s_waitcnt lgkmcnt(0)
    v_add_u32 v240, s73, v213
    v_add_u32 v241, s73, v214
    ds_read_u16 v232, v240
    ds_read_u16 v234, v240 offset:32
    ds_read_u16 v236, v240 offset:64
    ds_read_u16 v238, v240 offset:96
    s_mov_b64 exec, s[76:77]
    ds_read_u16 v217, v241 offset:2192
    ds_read_u16 v218, v241 offset:2194
    s_mov_b64 exec, -1

    v_mfma_f32_32x32x16_bf16 v[0:15], v[128:131], v[104:107], 0
    v_mfma_f32_32x32x16_bf16 v[0:15], v[112:115], v[64:67], v[0:15]
    v_mfma_f32_32x32x16_bf16 v[0:15], v[116:119], v[72:75], v[0:15]
    v_mfma_f32_32x32x16_bf16 v[0:15], v[120:123], v[80:83], v[0:15]
    v_mfma_f32_32x32x16_bf16 v[0:15], v[124:127], v[88:91], v[0:15]
    v_mfma_f32_32x32x16_bf16 v[0:15], v[132:135], v[96:99], v[0:15]
    s_mov_b32 s17, s12
    s_mov_b32 s72, s73
    s_mov_b64 s[74:75], s[76:77]
    s_setprio 3
    s_waitcnt lgkmcnt(0)

    s_mov_b32 m0, s5
    s_nop 0
    buffer_load_dwordx4 v[232:233], s[84:87], 0 idxen offen lds
    s_add_u32 m0, s5, 1024
    s_nop 0
    buffer_load_dwordx4 v[234:235], s[84:87], 0 idxen offen lds
    s_add_u32 m0, s5, 2048
    s_nop 0
    buffer_load_dwordx4 v[236:237], s[84:87], 0 idxen offen lds
    s_add_u32 m0, s5, 3072
    s_nop 0
    buffer_load_dwordx4 v[238:239], s[84:87], 0 idxen offen lds
    buffer_load_dwordx3 v[222:224], v217, s[40:43], 0 idxen
    s_nop 7
K2_TILE:
    s_cmp_ge_u32 s78, 10
    s_cbranch_scc1 K2_PRD
    s_setprio 2
    s_cmp_ge_u32 s78, 7
    s_cbranch_scc1 K2_PRD
    s_setprio 1
    s_cmp_ge_u32 s78, 4
    s_cbranch_scc1 K2_PRD
    s_setprio 0
K2_PRD:

    v_pk_mul_f32 v[160:161], v[0:1], s[92:93]
    v_pk_mul_f32 v[162:163], v[2:3], s[92:93]
    v_pk_mul_f32 v[164:165], v[4:5], s[92:93]
    v_pk_mul_f32 v[166:167], v[6:7], s[92:93]
    v_pk_mul_f32 v[168:169], v[8:9], s[92:93]
    v_pk_mul_f32 v[170:171], v[10:11], s[92:93]
    v_pk_mul_f32 v[172:173], v[12:13], s[92:93]
    v_pk_mul_f32 v[174:175], v[14:15], s[92:93]
    v_mfma_f32_32x32x16_bf16 v[48:63], v[152:155], v[136:139], v[48:63]
    v_exp_f32 v160, v160
    v_readlane_b32 s82, v229, s81
    v_exp_f32 v161, v161
    s_add_u32 s81, s81, 1
    v_exp_f32 v162, v162
    v_exp_f32 v163, v163
    v_mfma_f32_32x32x16_bf16 v[48:63], v[156:159], v[140:143], v[48:63]
    v_exp_f32 v164, v164
    s_bfe_u32 s19, s82, 0x6000f
    v_exp_f32 v165, v165
    s_and_b32 s73, s82, 0x7fff
    v_exp_f32 v166, v166
    s_bfm_b64 s[76:77], s19, 0
    v_exp_f32 v167, v167
    ds_read_b64_tr_b16 v[136:137], v212 offset:0
    ds_read_b64_tr_b16 v[138:139], v212 offset:512
    ds_read_b64_tr_b16 v[140:141], v212 offset:1024
    ds_read_b64_tr_b16 v[142:143], v212 offset:1536
    ds_write_b64 v219, v[220:221]
    v_mfma_f32_32x32x16_bf16 v[16:31], v[128:131], v[108:111], 0
    v_exp_f32 v168, v168
    s_lshr_b32 s12, s82, 21
    v_exp_f32 v169, v169
    s_mov_b32 s77, s76
    v_exp_f32 v170, v170
    v_exp_f32 v171, v171
    v_mfma_f32_32x32x16_bf16 v[16:31], v[112:115], v[68:71], v[16:31]
    v_exp_f32 v172, v172
    v_exp_f32 v173, v173
    v_exp_f32 v174, v174
    v_exp_f32 v175, v175
    v_pk_add_f32 v[160:161], v[160:161], 1.0 op_sel_hi:[1,0]
    v_pk_add_f32 v[162:163], v[162:163], 1.0 op_sel_hi:[1,0]
    v_pk_add_f32 v[164:165], v[164:165], 1.0 op_sel_hi:[1,0]
    v_pk_add_f32 v[166:167], v[166:167], 1.0 op_sel_hi:[1,0]
    v_pk_add_f32 v[168:169], v[168:169], 1.0 op_sel_hi:[1,0]
    v_pk_add_f32 v[170:171], v[170:171], 1.0 op_sel_hi:[1,0]
    v_pk_add_f32 v[172:173], v[172:173], 1.0 op_sel_hi:[1,0]
    v_pk_add_f32 v[174:175], v[174:175], 1.0 op_sel_hi:[1,0]
    v_mfma_f32_32x32x16_bf16 v[16:31], v[116:119], v[76:79], v[16:31]
    v_rcp_f32 v160, v160
    v_rcp_f32 v161, v161
    v_rcp_f32 v162, v162
    v_rcp_f32 v163, v163
    v_mfma_f32_32x32x16_bf16 v[16:31], v[120:123], v[84:87], v[16:31]
    v_rcp_f32 v164, v164
    v_rcp_f32 v165, v165
    v_rcp_f32 v166, v166
    v_rcp_f32 v167, v167
    v_mfma_f32_32x32x16_bf16 v[16:31], v[124:127], v[92:95], v[16:31]
    v_rcp_f32 v168, v168
    v_rcp_f32 v169, v169
    v_rcp_f32 v170, v170
    v_rcp_f32 v171, v171
    v_mfma_f32_32x32x16_bf16 v[16:31], v[132:135], v[100:103], v[16:31]
    v_rcp_f32 v172, v172
    v_rcp_f32 v173, v173
    v_rcp_f32 v174, v174
    v_rcp_f32 v175, v175
    s_cmp_eq_u32 s17, s16
    s_cbranch_scc1 K2_NOAOP

    s_lshl_b32 s19, s17, 11
    s_add_u32 s19, s19, 103440
    v_add_u32 v243, s19, v216
    ds_read_b128 v[104:107], v243
    ds_read_b128 v[108:111], v243 offset:1024
K2_NOAOP:
    s_lshl_b32 s20, s72, 1
    s_add_u32 s20, s20, 20496
    v_and_b32 v241, 0x70, v218
    v_lshl_add_u32 v242, v214, 1, s20
    ds_read_b96 v[226:228], v218 offset:384
    ds_read_b128 v[128:131], v241 offset:0
    s_mov_b64 exec, s[74:75]
    ds_read_b64 v[132:133], v242
    s_mov_b64 exec, -1
    v_lshrrev_b32 v241, 1, v241
    v_add_u32 v219, v215, v241
    s_waitcnt vmcnt(0)
    ds_read_b128 v[112:115], v208
    ds_read_b128 v[116:119], v209
    ds_read_b128 v[120:123], v210
    ds_read_b128 v[124:127], v211
    v_pk_mul_f32 v[160:161], v[0:1], v[160:161]
    v_pk_mul_f32 v[162:163], v[2:3], v[162:163]
    v_pk_mul_f32 v[164:165], v[4:5], v[164:165]
    v_pk_mul_f32 v[166:167], v[6:7], v[166:167]
    v_pk_mul_f32 v[168:169], v[8:9], v[168:169]
    v_pk_mul_f32 v[170:171], v[10:11], v[170:171]
    v_pk_mul_f32 v[172:173], v[12:13], v[172:173]
    v_pk_mul_f32 v[174:175], v[14:15], v[174:175]
    v_cvt_pk_bf16_f32 v144, v160, v161
    v_cvt_pk_bf16_f32 v145, v162, v163
    v_cvt_pk_bf16_f32 v146, v164, v165
    v_cvt_pk_bf16_f32 v147, v166, v167
    s_waitcnt lgkmcnt(6)
    v_pk_add_f32 v[240:241], v[226:227], v[222:223] neg_lo:[0,1] neg_hi:[0,1]
    v_sub_f32 v242, v228, v224
    v_cvt_pk_bf16_f32 v230, 1.0, v240
    v_cvt_pk_bf16_f32 v231, v241, v242
    v_mul_f32 v240, v240, v240
    v_fmac_f32 v240, v241, v241
    v_fmac_f32 v240, v242, v242
    s_mov_b64 exec, s[74:75]
    ds_write_b64 v219, v[230:231]
    s_mov_b64 exec, -1
    v_cvt_pk_bf16_f32 v134, v240, 0

    v_cvt_pk_bf16_f32 v148, v168, v169
    v_cvt_pk_bf16_f32 v149, v170, v171
    v_cvt_pk_bf16_f32 v150, v172, v173
    v_cvt_pk_bf16_f32 v151, v174, v175
    s_cmp_eq_u32 s18, s16
    s_cbranch_scc1 K2_NOFLUSH

    v_lshrrev_b32 v160, 4, v216
    v_lshrrev_b32 v161, 5, v160
    v_lshlrev_b32 v162, 7, v161

    ds_read_b128 v[176:179], v162 offset:128
    ds_read_b128 v[180:183], v162 offset:144
    ds_read_b128 v[184:187], v162 offset:160
    ds_read_b128 v[188:191], v162 offset:176
    ds_read_b128 v[192:195], v162 offset:192
    ds_read_b128 v[196:199], v162 offset:208
    ds_read_b128 v[200:203], v162 offset:224
    ds_read_b128 v[204:207], v162 offset:240
    v_bfe_u32 v163, v160, 2, 3
    s_lshl_b32 s19, s18, 3
    v_add_u32 v163, s19, v163
    v_mul_u32_u24 v164, 272, v163
    v_lshl_add_u32 v164, v161, 4, v164
    v_add_u32 v164, 58768, v164
    v_and_b32 v165, 3, v160
    v_lshlrev_b32 v163, 4, v163
    v_lshl_add_u32 v163, v165, 2, v163
    ds_read_b32 v165, v163 offset:57104
    s_mov_b32 s96, 0x11111111
    s_mov_b32 s97, 0x11111111
    s_mov_b32 s98, 0xeeeeeeee
    s_mov_b32 s99, 0

    s_cmp_eq_u32 s94, 0
    s_cbranch_scc1 K2_FLS1
    s_mov_b64 exec, s[96:97]

    ds_write_b128 v164, v[32:35] offset:0
    ds_write_b128 v164, v[36:39] offset:32
    ds_write_b128 v164, v[40:43] offset:64
    ds_write_b128 v164, v[44:47] offset:96
    ds_write_b128 v164, v[48:51] offset:128
    ds_write_b128 v164, v[52:55] offset:160
    ds_write_b128 v164, v[56:59] offset:192
    ds_write_b128 v164, v[60:63] offset:224
    s_mov_b64 exec, -1
    s_waitcnt lgkmcnt(8)
K2_FLS1:

    s_waitcnt lgkmcnt(9)

    s_cmp_lg_u32 s94, 0
    s_cbranch_scc1 K2_FLW1
    s_waitcnt lgkmcnt(0)
K2_FLW1:

    v_pk_mul_f32 v[166:167], v[176:177], v[32:33]
    v_pk_mul_f32 v[168:169], v[178:179], v[34:35]
    v_pk_fma_f32 v[166:167], v[180:181], v[36:37], v[166:167]
    v_pk_fma_f32 v[168:169], v[182:183], v[38:39], v[168:169]
    v_pk_fma_f32 v[166:167], v[184:185], v[40:41], v[166:167]
    v_pk_fma_f32 v[168:169], v[186:187], v[42:43], v[168:169]
    v_pk_fma_f32 v[166:167], v[188:189], v[44:45], v[166:167]
    v_pk_fma_f32 v[168:169], v[190:191], v[46:47], v[168:169]
    v_pk_fma_f32 v[166:167], v[192:193], v[48:49], v[166:167]
    v_pk_fma_f32 v[168:169], v[194:195], v[50:51], v[168:169]
    v_pk_fma_f32 v[166:167], v[196:197], v[52:53], v[166:167]
    v_pk_fma_f32 v[168:169], v[198:199], v[54:55], v[168:169]
    v_pk_fma_f32 v[166:167], v[200:201], v[56:57], v[166:167]
    v_pk_fma_f32 v[168:169], v[202:203], v[58:59], v[168:169]
    v_pk_fma_f32 v[166:167], v[204:205], v[60:61], v[166:167]
    v_pk_fma_f32 v[168:169], v[206:207], v[62:63], v[168:169]
    v_pk_add_f32 v[166:167], v[166:167], v[168:169]
    s_nop 0
    v_add_f32 v166, v166, v167
    s_nop 0
    v_mov_b32 v167, v166
    s_nop 1
    v_permlane32_swap_b32 v166, v167
    s_waitcnt lgkmcnt(8)
    v_add_f32 v166, v166, v167
    s_nop 0
    v_add_f32 v166, v166, v165
    s_mov_b64 exec, s[98:99]
    ds_write_b32 v163, v166 offset:57104

    s_cmp_lg_u32 s94, 0
    s_cbranch_scc1 K2_FLE1

    s_mov_b64 exec, s[96:97]
    ds_read_b128 v[176:179], v164 offset:0
    ds_read_b128 v[180:183], v164 offset:32
    ds_read_b128 v[184:187], v164 offset:64
    ds_read_b128 v[188:191], v164 offset:96
    ds_read_b128 v[192:195], v164 offset:128
    ds_read_b128 v[196:199], v164 offset:160
    ds_read_b128 v[200:203], v164 offset:192
    ds_read_b128 v[204:207], v164 offset:224
    s_waitcnt lgkmcnt(0)
    v_pk_add_f32 v[176:177], v[176:177], v[32:33]
    v_pk_add_f32 v[178:179], v[178:179], v[34:35]
    ds_write_b128 v164, v[176:179] offset:0
    v_pk_add_f32 v[180:181], v[180:181], v[36:37]
    v_pk_add_f32 v[182:183], v[182:183], v[38:39]
    ds_write_b128 v164, v[180:183] offset:32
    v_pk_add_f32 v[184:185], v[184:185], v[40:41]
    v_pk_add_f32 v[186:187], v[186:187], v[42:43]
    ds_write_b128 v164, v[184:187] offset:64
    v_pk_add_f32 v[188:189], v[188:189], v[44:45]
    v_pk_add_f32 v[190:191], v[190:191], v[46:47]
    ds_write_b128 v164, v[188:191] offset:96
    v_pk_add_f32 v[192:193], v[192:193], v[48:49]
    v_pk_add_f32 v[194:195], v[194:195], v[50:51]
    ds_write_b128 v164, v[192:195] offset:128
    v_pk_add_f32 v[196:197], v[196:197], v[52:53]
    v_pk_add_f32 v[198:199], v[198:199], v[54:55]
    ds_write_b128 v164, v[196:199] offset:160
    v_pk_add_f32 v[200:201], v[200:201], v[56:57]
    v_pk_add_f32 v[202:203], v[202:203], v[58:59]
    ds_write_b128 v164, v[200:203] offset:192
    v_pk_add_f32 v[204:205], v[204:205], v[60:61]
    v_pk_add_f32 v[206:207], v[206:207], v[62:63]
    ds_write_b128 v164, v[204:207] offset:224
K2_FLE1:
    s_mov_b64 exec, -1
    s_waitcnt lgkmcnt(0)
    v_mov_b64 v[32:33], 0
    v_mov_b64 v[34:35], 0
    v_mov_b64 v[36:37], 0
    v_mov_b64 v[38:39], 0
    v_mov_b64 v[40:41], 0
    v_mov_b64 v[42:43], 0
    v_mov_b64 v[44:45], 0
    v_mov_b64 v[46:47], 0
    v_mov_b64 v[48:49], 0
    v_mov_b64 v[50:51], 0
    v_mov_b64 v[52:53], 0
    v_mov_b64 v[54:55], 0
    v_mov_b64 v[56:57], 0
    v_mov_b64 v[58:59], 0
    v_mov_b64 v[60:61], 0
    v_mov_b64 v[62:63], 0
K2_NOFLUSH:
    s_waitcnt lgkmcnt(0)
    v_add_u32 v240, s73, v213
    v_add_u32 v241, s73, v214
    ds_read_u16 v232, v240
    ds_read_u16 v234, v240 offset:32
    ds_read_u16 v236, v240 offset:64
    ds_read_u16 v238, v240 offset:96
    s_mov_b64 exec, s[76:77]
    ds_read_u16 v217, v241 offset:2192
    ds_read_u16 v218, v241 offset:2194
    s_mov_b64 exec, -1

    v_pk_mul_f32 v[160:161], v[16:17], s[92:93]
    v_pk_mul_f32 v[162:163], v[18:19], s[92:93]
    v_pk_mul_f32 v[164:165], v[20:21], s[92:93]
    v_pk_mul_f32 v[166:167], v[22:23], s[92:93]
    v_pk_mul_f32 v[168:169], v[24:25], s[92:93]
    v_pk_mul_f32 v[170:171], v[26:27], s[92:93]
    v_pk_mul_f32 v[172:173], v[28:29], s[92:93]
    v_pk_mul_f32 v[174:175], v[30:31], s[92:93]
    v_mfma_f32_32x32x16_bf16 v[32:47], v[144:147], v[136:139], v[32:47]
    v_exp_f32 v160, v160
    v_exp_f32 v161, v161
    v_exp_f32 v162, v162
    v_exp_f32 v163, v163
    v_mfma_f32_32x32x16_bf16 v[32:47], v[148:151], v[140:143], v[32:47]
    v_exp_f32 v164, v164
    v_exp_f32 v165, v165
    v_exp_f32 v166, v166
    v_exp_f32 v167, v167
    v_mfma_f32_32x32x16_bf16 v[0:15], v[128:131], v[104:107], 0
    v_exp_f32 v168, v168
    v_exp_f32 v169, v169
    v_exp_f32 v170, v170
    v_exp_f32 v171, v171
    v_mfma_f32_32x32x16_bf16 v[0:15], v[112:115], v[64:67], v[0:15]
    v_exp_f32 v172, v172
    v_exp_f32 v173, v173
    v_exp_f32 v174, v174
    v_exp_f32 v175, v175
    s_waitcnt lgkmcnt(0)
    s_mov_b32 m0, s5
    s_nop 0
    buffer_load_dwordx4 v[232:233], s[84:87], 0 idxen offen lds
    s_add_u32 m0, s5, 1024
    s_nop 0
    buffer_load_dwordx4 v[234:235], s[84:87], 0 idxen offen lds
    s_add_u32 m0, s5, 2048
    s_nop 0
    buffer_load_dwordx4 v[236:237], s[84:87], 0 idxen offen lds
    s_add_u32 m0, s5, 3072
    s_nop 0
    buffer_load_dwordx4 v[238:239], s[84:87], 0 idxen offen lds
    buffer_load_dwordx3 v[222:224], v217, s[40:43], 0 idxen
    v_pk_add_f32 v[160:161], v[160:161], 1.0 op_sel_hi:[1,0]
    v_pk_add_f32 v[162:163], v[162:163], 1.0 op_sel_hi:[1,0]
    v_pk_add_f32 v[164:165], v[164:165], 1.0 op_sel_hi:[1,0]
    v_pk_add_f32 v[166:167], v[166:167], 1.0 op_sel_hi:[1,0]
    v_pk_add_f32 v[168:169], v[168:169], 1.0 op_sel_hi:[1,0]
    v_pk_add_f32 v[170:171], v[170:171], 1.0 op_sel_hi:[1,0]
    v_pk_add_f32 v[172:173], v[172:173], 1.0 op_sel_hi:[1,0]
    v_pk_add_f32 v[174:175], v[174:175], 1.0 op_sel_hi:[1,0]
    v_mfma_f32_32x32x16_bf16 v[0:15], v[116:119], v[72:75], v[0:15]
    v_rcp_f32 v160, v160
    v_rcp_f32 v161, v161
    v_rcp_f32 v162, v162
    v_rcp_f32 v163, v163
    v_mfma_f32_32x32x16_bf16 v[0:15], v[120:123], v[80:83], v[0:15]
    v_rcp_f32 v164, v164
    v_rcp_f32 v165, v165
    v_rcp_f32 v166, v166
    v_rcp_f32 v167, v167
    v_mfma_f32_32x32x16_bf16 v[0:15], v[124:127], v[88:91], v[0:15]
    v_rcp_f32 v168, v168
    v_rcp_f32 v169, v169
    v_rcp_f32 v170, v170
    v_rcp_f32 v171, v171
    v_mfma_f32_32x32x16_bf16 v[0:15], v[132:135], v[96:99], v[0:15]
    v_rcp_f32 v172, v172
    v_rcp_f32 v173, v173
    v_rcp_f32 v174, v174
    v_rcp_f32 v175, v175
    v_pk_mul_f32 v[160:161], v[16:17], v[160:161]
    v_pk_mul_f32 v[162:163], v[18:19], v[162:163]
    v_pk_mul_f32 v[164:165], v[20:21], v[164:165]
    v_pk_mul_f32 v[166:167], v[22:23], v[166:167]
    v_pk_mul_f32 v[168:169], v[24:25], v[168:169]
    v_pk_mul_f32 v[170:171], v[26:27], v[170:171]
    v_pk_mul_f32 v[172:173], v[28:29], v[172:173]
    v_pk_mul_f32 v[174:175], v[30:31], v[174:175]
    v_cvt_pk_bf16_f32 v152, v160, v161
    v_cvt_pk_bf16_f32 v153, v162, v163
    v_cvt_pk_bf16_f32 v154, v164, v165
    v_cvt_pk_bf16_f32 v155, v166, v167
    v_cvt_pk_bf16_f32 v156, v168, v169
    v_cvt_pk_bf16_f32 v157, v170, v171
    v_cvt_pk_bf16_f32 v158, v172, v173
    v_cvt_pk_bf16_f32 v159, v174, v175
    s_mov_b32 s18, s16
    s_mov_b32 s16, s17
    s_mov_b32 s17, s12
    s_mov_b32 s72, s73
    s_mov_b64 s[74:75], s[76:77]
    s_sub_u32 s78, s78, 1
    s_cmp_lg_u32 s78, 0
    s_cbranch_scc1 K2_TILE

    v_mfma_f32_32x32x16_bf16 v[48:63], v[152:155], v[136:139], v[48:63]
    v_mfma_f32_32x32x16_bf16 v[48:63], v[156:159], v[140:143], v[48:63]
    s_setprio 0
    s_waitcnt vmcnt(0) lgkmcnt(0)
    ds_write_b64 v219, v[220:221]
    s_nop 7
    s_cmp_lg_u32 s79, 0
    s_cbranch_scc1 K2_CONT

    v_lshrrev_b32 v160, 4, v216
    v_lshrrev_b32 v161, 5, v160
    v_lshlrev_b32 v162, 7, v161

    ds_read_b128 v[176:179], v162 offset:128
    ds_read_b128 v[180:183], v162 offset:144
    ds_read_b128 v[184:187], v162 offset:160
    ds_read_b128 v[188:191], v162 offset:176
    ds_read_b128 v[192:195], v162 offset:192
    ds_read_b128 v[196:199], v162 offset:208
    ds_read_b128 v[200:203], v162 offset:224
    ds_read_b128 v[204:207], v162 offset:240
    v_bfe_u32 v163, v160, 2, 3
    s_lshl_b32 s19, s18, 3
    v_add_u32 v163, s19, v163
    v_mul_u32_u24 v164, 272, v163
    v_lshl_add_u32 v164, v161, 4, v164
    v_add_u32 v164, 58768, v164
    v_and_b32 v165, 3, v160
    v_lshlrev_b32 v163, 4, v163
    v_lshl_add_u32 v163, v165, 2, v163
    ds_read_b32 v165, v163 offset:57104
    s_mov_b32 s96, 0x11111111
    s_mov_b32 s97, 0x11111111
    s_mov_b32 s98, 0xeeeeeeee
    s_mov_b32 s99, 0

    s_cmp_eq_u32 s94, 0
    s_cbranch_scc1 K2_FLS2
    s_mov_b64 exec, s[96:97]

    ds_write_b128 v164, v[32:35] offset:0
    ds_write_b128 v164, v[36:39] offset:32
    ds_write_b128 v164, v[40:43] offset:64
    ds_write_b128 v164, v[44:47] offset:96
    ds_write_b128 v164, v[48:51] offset:128
    ds_write_b128 v164, v[52:55] offset:160
    ds_write_b128 v164, v[56:59] offset:192
    ds_write_b128 v164, v[60:63] offset:224
    s_mov_b64 exec, -1
    s_waitcnt lgkmcnt(8)
K2_FLS2:

    s_waitcnt lgkmcnt(9)

    s_cmp_lg_u32 s94, 0
    s_cbranch_scc1 K2_FLW2
    s_waitcnt lgkmcnt(0)
K2_FLW2:

    v_pk_mul_f32 v[166:167], v[176:177], v[32:33]
    v_pk_mul_f32 v[168:169], v[178:179], v[34:35]
    v_pk_fma_f32 v[166:167], v[180:181], v[36:37], v[166:167]
    v_pk_fma_f32 v[168:169], v[182:183], v[38:39], v[168:169]
    v_pk_fma_f32 v[166:167], v[184:185], v[40:41], v[166:167]
    v_pk_fma_f32 v[168:169], v[186:187], v[42:43], v[168:169]
    v_pk_fma_f32 v[166:167], v[188:189], v[44:45], v[166:167]
    v_pk_fma_f32 v[168:169], v[190:191], v[46:47], v[168:169]
    v_pk_fma_f32 v[166:167], v[192:193], v[48:49], v[166:167]
    v_pk_fma_f32 v[168:169], v[194:195], v[50:51], v[168:169]
    v_pk_fma_f32 v[166:167], v[196:197], v[52:53], v[166:167]
    v_pk_fma_f32 v[168:169], v[198:199], v[54:55], v[168:169]
    v_pk_fma_f32 v[166:167], v[200:201], v[56:57], v[166:167]
    v_pk_fma_f32 v[168:169], v[202:203], v[58:59], v[168:169]
    v_pk_fma_f32 v[166:167], v[204:205], v[60:61], v[166:167]
    v_pk_fma_f32 v[168:169], v[206:207], v[62:63], v[168:169]
    v_pk_add_f32 v[166:167], v[166:167], v[168:169]
    s_nop 0
    v_add_f32 v166, v166, v167
    s_nop 0
    v_mov_b32 v167, v166
    s_nop 1
    v_permlane32_swap_b32 v166, v167
    s_waitcnt lgkmcnt(8)
    v_add_f32 v166, v166, v167
    s_nop 0
    v_add_f32 v166, v166, v165
    s_mov_b64 exec, s[98:99]
    ds_write_b32 v163, v166 offset:57104

    s_cmp_lg_u32 s94, 0
    s_cbranch_scc1 K2_FLE2

    s_mov_b64 exec, s[96:97]
    ds_read_b128 v[176:179], v164 offset:0
    ds_read_b128 v[180:183], v164 offset:32
    ds_read_b128 v[184:187], v164 offset:64
    ds_read_b128 v[188:191], v164 offset:96
    ds_read_b128 v[192:195], v164 offset:128
    ds_read_b128 v[196:199], v164 offset:160
    ds_read_b128 v[200:203], v164 offset:192
    ds_read_b128 v[204:207], v164 offset:224
    s_waitcnt lgkmcnt(0)
    v_pk_add_f32 v[176:177], v[176:177], v[32:33]
    v_pk_add_f32 v[178:179], v[178:179], v[34:35]
    ds_write_b128 v164, v[176:179] offset:0
    v_pk_add_f32 v[180:181], v[180:181], v[36:37]
    v_pk_add_f32 v[182:183], v[182:183], v[38:39]
    ds_write_b128 v164, v[180:183] offset:32
    v_pk_add_f32 v[184:185], v[184:185], v[40:41]
    v_pk_add_f32 v[186:187], v[186:187], v[42:43]
    ds_write_b128 v164, v[184:187] offset:64
    v_pk_add_f32 v[188:189], v[188:189], v[44:45]
    v_pk_add_f32 v[190:191], v[190:191], v[46:47]
    ds_write_b128 v164, v[188:191] offset:96
    v_pk_add_f32 v[192:193], v[192:193], v[48:49]
    v_pk_add_f32 v[194:195], v[194:195], v[50:51]
    ds_write_b128 v164, v[192:195] offset:128
    v_pk_add_f32 v[196:197], v[196:197], v[52:53]
    v_pk_add_f32 v[198:199], v[198:199], v[54:55]
    ds_write_b128 v164, v[196:199] offset:160
    v_pk_add_f32 v[200:201], v[200:201], v[56:57]
    v_pk_add_f32 v[202:203], v[202:203], v[58:59]
    ds_write_b128 v164, v[200:203] offset:192
    v_pk_add_f32 v[204:205], v[204:205], v[60:61]
    v_pk_add_f32 v[206:207], v[206:207], v[62:63]
    ds_write_b128 v164, v[204:207] offset:224
K2_FLE2:
    s_mov_b64 exec, -1
    s_branch K2_NOCONT
K2_CONT:
    s_lshl_b32 s19, s70, 2
    v_mov_b32 v160, s19
    v_mov_b32 v161, 1
    v_mov_b32 v163, 2120
    s_mov_b64 exec, 1
    ds_add_rtn_u32 v162, v160, v161 offset:2128
    s_waitcnt lgkmcnt(0)
    ds_max_u32 v163, v162
    v_readfirstlane_b32 s23, v162
    s_mov_b64 exec, -1
K2_NOCONT:

    v_lshrrev_b32 v240, 4, v216
    s_lshr_b32 s19, s3, 1
    s_and_b32 s20, s3, 1
    v_and_b32 v232, 31, v240
    v_lshrrev_b32 v233, 5, v240
    s_lshl_b32 s21, s19, 5
    v_add_u32 v232, s21, v232
    v_add_u32 v241, s4, v232
    v_lshlrev_b32 v234, 7, v241
    v_lshl_add_u32 v241, v233, 4, v234

    buffer_load_dwordx4 v[0:3], v241, s[36:39], 0 offen offset:0
    buffer_load_dwordx4 v[4:7], v241, s[36:39], 0 offen offset:32
    buffer_load_dwordx4 v[8:11], v241, s[36:39], 0 offen offset:64
    buffer_load_dwordx4 v[12:15], v241, s[36:39], 0 offen offset:96
    s_lshl_b32 s21, s20, 6
    v_lshl_add_u32 v235, v233, 5, v234
    v_add_u32 v235, s21, v235
    buffer_load_dwordx4 v[112:115], v235, s[36:39], 0 offen
    buffer_load_dwordx4 v[116:119], v235, s[36:39], 0 offen offset:16
    s_lshl_b32 s21, s20, 10
    s_add_u32 s21, s21, 11550720
    v_add_u32 v242, s21, v216

    v_add_u32 v243, 0, v242
    buffer_load_dwordx4 v[120:123], v243, s[44:47], 0 offen offset:0
    buffer_load_dwordx4 v[124:127], v243, s[44:47], 0 offen offset:2048
    v_add_u32 v243, 4096, v242
    buffer_load_dwordx4 v[128:131], v243, s[44:47], 0 offen offset:0
    buffer_load_dwordx4 v[132:135], v243, s[44:47], 0 offen offset:2048
    v_add_u32 v243, 8192, v242
    buffer_load_dwordx4 v[136:139], v243, s[44:47], 0 offen offset:0
    buffer_load_dwordx4 v[140:143], v243, s[44:47], 0 offen offset:2048
    v_add_u32 v243, 12288, v242
    buffer_load_dwordx4 v[144:147], v243, s[44:47], 0 offen offset:0
    buffer_load_dwordx4 v[148:151], v243, s[44:47], 0 offen offset:2048
    s_waitcnt lgkmcnt(0)
    s_barrier
    v_mov_b32 v160, 2112
    ds_read_b96 v[162:164], v160
    s_waitcnt lgkmcnt(0)
    v_readfirstlane_b32 s16, v162
    v_readfirstlane_b32 s17, v163
    v_readfirstlane_b32 s18, v164
    s_mov_b32 s22, 0
K2_PHASE:
    s_cmp_lg_u32 s23, s22
    s_cbranch_scc1 K2_PH_SKIP

    v_lshrrev_b32 v160, 4, v216
    v_lshrrev_b32 v161, 5, v160
    v_lshlrev_b32 v162, 7, v161

    ds_read_b128 v[176:179], v162 offset:128
    ds_read_b128 v[180:183], v162 offset:144
    ds_read_b128 v[184:187], v162 offset:160
    ds_read_b128 v[188:191], v162 offset:176
    ds_read_b128 v[192:195], v162 offset:192
    ds_read_b128 v[196:199], v162 offset:208
    ds_read_b128 v[200:203], v162 offset:224
    ds_read_b128 v[204:207], v162 offset:240
    v_bfe_u32 v163, v160, 2, 3
    s_lshl_b32 s19, s70, 3
    v_add_u32 v163, s19, v163
    v_mul_u32_u24 v164, 272, v163
    v_lshl_add_u32 v164, v161, 4, v164
    v_add_u32 v164, 58768, v164
    v_and_b32 v165, 3, v160
    v_lshlrev_b32 v163, 4, v163
    v_lshl_add_u32 v163, v165, 2, v163
    ds_read_b32 v165, v163 offset:57104
    s_mov_b32 s96, 0x11111111
    s_mov_b32 s97, 0x11111111
    s_mov_b32 s98, 0xeeeeeeee
    s_mov_b32 s99, 0

    s_waitcnt lgkmcnt(1)

    v_pk_mul_f32 v[166:167], v[176:177], v[32:33]
    v_pk_mul_f32 v[168:169], v[178:179], v[34:35]
    v_pk_fma_f32 v[166:167], v[180:181], v[36:37], v[166:167]
    v_pk_fma_f32 v[168:169], v[182:183], v[38:39], v[168:169]
    v_pk_fma_f32 v[166:167], v[184:185], v[40:41], v[166:167]
    v_pk_fma_f32 v[168:169], v[186:187], v[42:43], v[168:169]
    v_pk_fma_f32 v[166:167], v[188:189], v[44:45], v[166:167]
    v_pk_fma_f32 v[168:169], v[190:191], v[46:47], v[168:169]
    v_pk_fma_f32 v[166:167], v[192:193], v[48:49], v[166:167]
    v_pk_fma_f32 v[168:169], v[194:195], v[50:51], v[168:169]
    v_pk_fma_f32 v[166:167], v[196:197], v[52:53], v[166:167]
    v_pk_fma_f32 v[168:169], v[198:199], v[54:55], v[168:169]
    v_pk_fma_f32 v[166:167], v[200:201], v[56:57], v[166:167]
    v_pk_fma_f32 v[168:169], v[202:203], v[58:59], v[168:169]
    v_pk_fma_f32 v[166:167], v[204:205], v[60:61], v[166:167]
    v_pk_fma_f32 v[168:169], v[206:207], v[62:63], v[168:169]
    v_pk_add_f32 v[166:167], v[166:167], v[168:169]
    s_nop 0
    v_add_f32 v166, v166, v167
    s_nop 0
    v_mov_b32 v167, v166
    s_nop 1
    v_permlane32_swap_b32 v166, v167
    s_waitcnt lgkmcnt(0)
    v_add_f32 v166, v166, v167
    s_nop 0
    v_add_f32 v166, v166, v165
    s_mov_b64 exec, s[98:99]
    ds_write_b32 v163, v166 offset:57104

    s_mov_b64 exec, s[96:97]
    ds_read_b128 v[176:179], v164 offset:0
    ds_read_b128 v[180:183], v164 offset:32
    ds_read_b128 v[184:187], v164 offset:64
    ds_read_b128 v[188:191], v164 offset:96
    ds_read_b128 v[192:195], v164 offset:128
    ds_read_b128 v[196:199], v164 offset:160
    ds_read_b128 v[200:203], v164 offset:192
    ds_read_b128 v[204:207], v164 offset:224
    s_waitcnt lgkmcnt(0)
    v_pk_add_f32 v[176:177], v[176:177], v[32:33]
    v_pk_add_f32 v[178:179], v[178:179], v[34:35]
    ds_write_b128 v164, v[176:179] offset:0
    v_pk_add_f32 v[180:181], v[180:181], v[36:37]
    v_pk_add_f32 v[182:183], v[182:183], v[38:39]
    ds_write_b128 v164, v[180:183] offset:32
    v_pk_add_f32 v[184:185], v[184:185], v[40:41]
    v_pk_add_f32 v[186:187], v[186:187], v[42:43]
    ds_write_b128 v164, v[184:187] offset:64
    v_pk_add_f32 v[188:189], v[188:189], v[44:45]
    v_pk_add_f32 v[190:191], v[190:191], v[46:47]
    ds_write_b128 v164, v[188:191] offset:96
    v_pk_add_f32 v[192:193], v[192:193], v[48:49]
    v_pk_add_f32 v[194:195], v[194:195], v[50:51]
    ds_write_b128 v164, v[192:195] offset:128
    v_pk_add_f32 v[196:197], v[196:197], v[52:53]
    v_pk_add_f32 v[198:199], v[198:199], v[54:55]
    ds_write_b128 v164, v[196:199] offset:160
    v_pk_add_f32 v[200:201], v[200:201], v[56:57]
    v_pk_add_f32 v[202:203], v[202:203], v[58:59]
    ds_write_b128 v164, v[200:203] offset:192
    v_pk_add_f32 v[204:205], v[204:205], v[60:61]
    v_pk_add_f32 v[206:207], v[206:207], v[62:63]
    ds_write_b128 v164, v[204:207] offset:224
    s_mov_b64 exec, -1
K2_PH_SKIP:
    s_waitcnt lgkmcnt(0)
    s_barrier
    s_add_u32 s22, s22, 1
    s_cmp_le_u32 s22, s18
    s_cbranch_scc1 K2_PHASE
    s_or_b32 s21, s16, s17
    s_cmp_eq_u32 s21, 0
    s_cbranch_scc1 K2_EPI
    s_waitcnt vmcnt(0)
    s_mov_b32 s94, 0
    s_cmp_lg_u32 s16, 0
    s_cbranch_scc1 K2_SAMEJ
    s_add_u32 s6, s6, 32
    v_mov_b32 v225, 0
K2_SAMEJ:
    v_mbcnt_lo_u32_b32 v1, -1, 0
    v_mbcnt_hi_u32_b32 v1, -1, v1
    v_lshlrev_b32 v2, 2, v1
    v_mov_b32 v3, 0
    v_cmp_gt_u32 vcc, 36, v1
    s_and_saveexec_b64 s[96:97], vcc
    ds_write_b32 v2, v3 offset:2048
    s_mov_b64 exec, s[96:97]
    s_branch K2_ROUND

K2_EPI:
    v_mul_u32_u24 v240, 272, v232
    v_lshl_add_u32 v240, v233, 5, v240
    v_add_u32 v240, 58768, v240

    ds_read_b128 v[32:35], v240 offset:0
    ds_read_b128 v[36:39], v240 offset:16
    ds_read_b128 v[40:43], v240 offset:64
    ds_read_b128 v[44:47], v240 offset:80
    ds_read_b128 v[48:51], v240 offset:128
    ds_read_b128 v[52:55], v240 offset:144
    ds_read_b128 v[56:59], v240 offset:192
    ds_read_b128 v[60:63], v240 offset:208
    v_lshrrev_b32 v160, 4, v216
    s_lshl_b32 s19, s3, 6
    v_add_u32 v160, s19, v160
    v_mul_u32_u24 v161, 0xaaab, v160
    v_lshrrev_b32 v161, 17, v161
    v_mul_u32_u24 v162, 3, v161
    v_sub_u32 v162, v160, v162
    v_min_u32 v163, 103, v161
    v_lshlrev_b32 v163, 4, v163
    v_lshl_add_u32 v163, v162, 2, v163
    ds_read_b32 v164, v163 offset:384
    ds_read_b32 v165, v163 offset:57108
    s_mul_i32 s20, s4, 6
    s_add_u32 s20, s20, 3200000
    v_lshl_add_u32 v166, v160, 1, s20
    v_add_u32 v167, s4, v161
    s_movk_i32 s21, 25000
    v_cmp_gt_u32 vcc, 98, v161
    v_cmp_gt_u32 s[96:97], s21, v167
    s_waitcnt lgkmcnt(2)

    v_cvt_pk_bf16_f32 v16, v32, v33
    v_cvt_pk_bf16_f32 v17, v34, v35
    v_cvt_pk_bf16_f32 v18, v36, v37
    v_cvt_pk_bf16_f32 v19, v38, v39
    v_cvt_pk_bf16_f32 v20, v40, v41
    v_cvt_pk_bf16_f32 v21, v42, v43
    v_cvt_pk_bf16_f32 v22, v44, v45
    v_cvt_pk_bf16_f32 v23, v46, v47
    v_cvt_pk_bf16_f32 v24, v48, v49
    v_cvt_pk_bf16_f32 v25, v50, v51
    v_cvt_pk_bf16_f32 v26, v52, v53
    v_cvt_pk_bf16_f32 v27, v54, v55
    v_cvt_pk_bf16_f32 v28, v56, v57
    v_cvt_pk_bf16_f32 v29, v58, v59
    v_cvt_pk_bf16_f32 v30, v60, v61
    v_cvt_pk_bf16_f32 v31, v62, v63
    s_waitcnt vmcnt(0) lgkmcnt(0)
    v_add_f32 v164, v164, v165
    v_cvt_pk_bf16_f32 v164, v164, 0
    s_and_b64 exec, vcc, s[96:97]
    buffer_store_short v164, v166, s[52:55], 0 offen
    s_mov_b64 exec, -1
    s_nop 3

    v_mfma_f32_32x32x16_bf16 v[32:47], v[120:123], v[0:3], 0
    v_mfma_f32_32x32x16_bf16 v[32:47], v[124:127], v[4:7], v[32:47]
    v_mfma_f32_32x32x16_bf16 v[32:47], v[128:131], v[8:11], v[32:47]
    v_mfma_f32_32x32x16_bf16 v[32:47], v[132:135], v[12:15], v[32:47]
    v_mfma_f32_32x32x16_bf16 v[32:47], v[136:139], v[16:19], v[32:47]
    v_mfma_f32_32x32x16_bf16 v[32:47], v[140:143], v[20:23], v[32:47]
    v_mfma_f32_32x32x16_bf16 v[32:47], v[144:147], v[24:27], v[32:47]
    v_mfma_f32_32x32x16_bf16 v[32:47], v[148:151], v[28:31], v[32:47]
    v_lshlrev_b32 v64, 16, v112
    v_and_b32 v65, 0xffff0000, v112
    v_lshlrev_b32 v66, 16, v113
    v_and_b32 v67, 0xffff0000, v113
    v_lshlrev_b32 v68, 16, v114
    v_and_b32 v69, 0xffff0000, v114
    v_lshlrev_b32 v70, 16, v115
    v_and_b32 v71, 0xffff0000, v115
    v_lshlrev_b32 v72, 16, v116
    v_and_b32 v73, 0xffff0000, v116
    v_lshlrev_b32 v74, 16, v117
    v_and_b32 v75, 0xffff0000, v117
    v_lshlrev_b32 v76, 16, v118
    v_and_b32 v77, 0xffff0000, v118
    v_lshlrev_b32 v78, 16, v119
    v_and_b32 v79, 0xffff0000, v119
    v_mul_f32 v48, s9, v32
    v_mul_f32 v49, s9, v33
    v_mul_f32 v50, s9, v34
    v_mul_f32 v51, s9, v35
    v_mul_f32 v52, s9, v36
    v_mul_f32 v53, s9, v37
    v_mul_f32 v54, s9, v38
    v_mul_f32 v55, s9, v39
    v_mul_f32 v56, s9, v40
    v_mul_f32 v57, s9, v41
    v_mul_f32 v58, s9, v42
    v_mul_f32 v59, s9, v43
    v_mul_f32 v60, s9, v44
    v_mul_f32 v61, s9, v45
    v_mul_f32 v62, s9, v46
    v_mul_f32 v63, s9, v47
    v_exp_f32 v48, v48
    v_exp_f32 v49, v49
    v_exp_f32 v50, v50
    v_exp_f32 v51, v51
    v_exp_f32 v52, v52
    v_exp_f32 v53, v53
    v_exp_f32 v54, v54
    v_exp_f32 v55, v55
    v_exp_f32 v56, v56
    v_exp_f32 v57, v57
    v_exp_f32 v58, v58
    v_exp_f32 v59, v59
    v_exp_f32 v60, v60
    v_exp_f32 v61, v61
    v_exp_f32 v62, v62
    v_exp_f32 v63, v63
    v_add_f32 v48, 1.0, v48
    v_add_f32 v49, 1.0, v49
    v_add_f32 v50, 1.0, v50
    v_add_f32 v51, 1.0, v51
    v_add_f32 v52, 1.0, v52
    v_add_f32 v53, 1.0, v53
    v_add_f32 v54, 1.0, v54
    v_add_f32 v55, 1.0, v55
    v_add_f32 v56, 1.0, v56
    v_add_f32 v57, 1.0, v57
    v_add_f32 v58, 1.0, v58
    v_add_f32 v59, 1.0, v59
    v_add_f32 v60, 1.0, v60
    v_add_f32 v61, 1.0, v61
    v_add_f32 v62, 1.0, v62
    v_add_f32 v63, 1.0, v63
    v_rcp_f32 v48, v48
    v_rcp_f32 v49, v49
    v_rcp_f32 v50, v50
    v_rcp_f32 v51, v51
    v_rcp_f32 v52, v52
    v_rcp_f32 v53, v53
    v_rcp_f32 v54, v54
    v_rcp_f32 v55, v55
    v_rcp_f32 v56, v56
    v_rcp_f32 v57, v57
    v_rcp_f32 v58, v58
    v_rcp_f32 v59, v59
    v_rcp_f32 v60, v60
    v_rcp_f32 v61, v61
    v_rcp_f32 v62, v62
    v_rcp_f32 v63, v63
    v_fma_f32 v48, v32, v48, v64
    v_fma_f32 v49, v33, v49, v65
    v_fma_f32 v50, v34, v50, v66
    v_fma_f32 v51, v35, v51, v67
    v_fma_f32 v52, v36, v52, v68
    v_fma_f32 v53, v37, v53, v69
    v_fma_f32 v54, v38, v54, v70
    v_fma_f32 v55, v39, v55, v71
    v_fma_f32 v56, v40, v56, v72
    v_fma_f32 v57, v41, v57, v73
    v_fma_f32 v58, v42, v58, v74
    v_fma_f32 v59, v43, v59, v75
    v_fma_f32 v60, v44, v60, v76
    v_fma_f32 v61, v45, v61, v77
    v_fma_f32 v62, v46, v62, v78
    v_fma_f32 v63, v47, v63, v79
    v_cvt_pk_bf16_f32 v80, v48, v49
    v_cvt_pk_bf16_f32 v81, v50, v51
    v_cvt_pk_bf16_f32 v82, v52, v53
    v_cvt_pk_bf16_f32 v83, v54, v55
    v_cvt_pk_bf16_f32 v84, v56, v57
    v_cvt_pk_bf16_f32 v85, v58, v59
    v_cvt_pk_bf16_f32 v86, v60, v61
    v_cvt_pk_bf16_f32 v87, v62, v63
    v_cmp_gt_u32 vcc, 98, v232
    v_cmp_gt_u32 s[96:97], s38, v234
    s_and_b64 exec, vcc, s[96:97]
    s_cbranch_execz K2_FIN
    buffer_store_dwordx4 v[80:83], v235, s[52:55], 0 offen
    buffer_store_dwordx4 v[84:87], v235, s[52:55], 0 offen offset:16

K2_FIN:
K2_END:
    s_endpgm
K2_CODE_END:
.section .rodata,"a"
.p2align 6
.amdhsa_kernel bin_kernel
  .amdhsa_next_free_vgpr 48
  .amdhsa_next_free_sgpr 64
  .amdhsa_accum_offset 48
  .amdhsa_group_segment_fixed_size 0
  .amdhsa_kernarg_size 88
  .amdhsa_user_sgpr_count 2
  .amdhsa_user_sgpr_kernarg_segment_ptr 1
  .amdhsa_system_sgpr_workgroup_id_x 1
.end_amdhsa_kernel
.p2align 6
.amdhsa_kernel egnn_kernel
  .amdhsa_next_free_vgpr 244
  .amdhsa_next_free_sgpr 102
  .amdhsa_accum_offset 244
  .amdhsa_group_segment_fixed_size 0
  .amdhsa_kernarg_size 88
  .amdhsa_user_sgpr_count 2
  .amdhsa_user_sgpr_kernarg_segment_ptr 1
  .amdhsa_system_sgpr_workgroup_id_x 1
.end_amdhsa_kernel
```
